```python
import torch

def _softmax(x, axis=-1):
    return torch.softmax(x, dim=axis)
def _gelu(x):
    return torch.nn.functional.gelu(x, approximate="tanh")
def _silu(x):
    return torch.nn.functional.silu(x)
def _sigmoid(x):
    return torch.sigmoid(x)
def _layernorm(x, axis=-1, eps=1e-5):
    m = x.mean(dim=axis, keepdim=True)
    v = x.var(dim=axis, keepdim=True, unbiased=False)
    return (x - m) / torch.sqrt(v + eps)
def _scatter_add(tgt, idx, src, axis=0):
    return tgt.clone().index_add_(axis, idx, src)
def _segment_sum(src, seg, n):
    out = torch.zeros((n,) + src.shape[1:], dtype=src.dtype)
    return out.index_add_(0, seg, src)
def _pad(x, pw):
    flat = tuple(v for pair in reversed(pw) for v in pair)
    return torch.nn.functional.pad(x, flat)

kernel_name = 'gated_mix__linear_attn_block__glu_gated_glu__prompt'

def setup_inputs():

    _w = (lambda a: (lambda t: t.to(torch.bfloat16) if t.is_floating_point() else t)(torch.as_tensor(a)))
    def _A_setup():
        B, S, D = 1, 2048, 640
        return {
            "x": _w((lambda *s: torch.randn(*s, dtype=torch.bfloat16) * 0.05)(B, S, D)),
            "wqkv": _w((lambda *s: torch.randn(*s, dtype=torch.bfloat16) * 0.8)(D, 3 * D)),
            "wo": _w((lambda *s: torch.randn(*s, dtype=torch.bfloat16) * 0.2)(D, D)),
        }
    _A_in = _A_setup()

    def _B_setup():
        B, S, D, F = 1, 2048, 640, 1536
        return {
            "x": _w((lambda *s: torch.randn(*s, dtype=torch.bfloat16) * 0.05)(B, S, D)),
            "w_gate": _w((lambda *s: torch.randn(*s, dtype=torch.bfloat16) * 0.4)(D, F)),
            "w_up": _w((lambda *s: torch.randn(*s, dtype=torch.bfloat16) * 0.05)(D, F)),
            "w_down": _w((lambda *s: torch.randn(*s, dtype=torch.bfloat16) * 0.05)(F, D)),
        }
    _B_in = _B_setup()

    return {
        "A_x": _A_in["x"],
        "A_wqkv": _A_in["wqkv"],
        "A_wo": _A_in["wo"],
        "B_x": _B_in["x"],
        "B_w_gate": _B_in["w_gate"],
        "B_w_up": _B_in["w_up"],
        "B_w_down": _B_in["w_down"],
        "gate_w": _w((lambda *s: torch.randn(*s, dtype=torch.bfloat16) * 0.05)(640) * 16.0),
    }

def reference(A_x, A_wqkv, A_wo, B_x, B_w_gate, B_w_up, B_w_down, gate_w):
    def _A_ref(x, wqkv, wo):
        B, S, D = x.shape
        H = 32; Dh = D // H
        qkv = (lambda x, *d: x.permute(*d))((x @ wqkv).reshape(B, S, 3, H, Dh), 2, 0, 3, 1, 4)
        q, k, v = qkv[0], qkv[1], qkv[2]
        phi = lambda t: torch.where(t > 0, t + 1, torch.exp(t)) + 1e-6
        pq, pk = phi(q), phi(k)
        kv = torch.einsum("bhsd,bhse->bhde", pk, v)
        z = torch.einsum("bhsd->bhd", pk)
        num = torch.einsum("bhqd,bhde->bhqe", pq, kv)
        den = torch.einsum("bhqd,bhd->bhq", pq, z)[..., None] + 1e-6
        o = num / den
        return (lambda x, *d: x.permute(*d))(o, 0, 2, 1, 3).reshape(B, S, D) @ wo

    def _B_ref(x, w_gate, w_up, w_down):
        g = torch.einsum("bsd,df->bsf", x, w_gate)
        u = torch.einsum("bsd,df->bsf", x, w_up)
        h = _sigmoid(g) * u
        return torch.einsum("bsf,fd->bsd", h, w_down)

    x = A_x
    g = _sigmoid((x * gate_w).sum(-1, keepdims=True))
    a = _A_ref(x, A_wqkv, A_wo)
    b = _B_ref(x, B_w_gate, B_w_up, B_w_down)
    return g * a + (1 - g) * b
```

```asm
; @launch grid=(256,1,1) block=(512,1,1) lds=163840
.amdgcn_target "amdgcn-amd-amdhsa--gfx950"
.text
    .globl gated_mix__linear_attn_block__glu_gated_glu__prompt_kernel
    .p2align 8
    .type gated_mix__linear_attn_block__glu_gated_glu__prompt_kernel,@function
gated_mix__linear_attn_block__glu_gated_glu__prompt_kernel:
    s_cmp_ge_u32 s2, 256
    s_cbranch_scc1 L_end
    s_load_dwordx4 s[4:7], s[0:1], 0
    s_load_dwordx4 s[8:11], s[0:1], 32
    s_load_dwordx4 s[12:15], s[0:1], 48
    s_load_dwordx2 s[16:17], s[0:1], 80
    v_lshrrev_b32 v1, 6, v0
    v_and_b32 v2, 63, v0
    s_bfe_u32 s23, s2, 0x30003
    s_and_b32 s18, s2, 1
    s_lshl_b32 s18, s18, 3
    s_add_u32 s18, s18, s23
    v_readfirstlane_b32 s21, v1
    s_bfe_u32 s19, s2, 0x20001
    s_lshr_b32 s20, s2, 6
    s_mul_i32 s22, s19, 3
    s_add_u32 s22, s22, s20
    s_sub_u32 s22, s22, 1
    s_cmp_eq_u32 s22, 10
    s_cselect_b32 s55, 1, 0
    s_cmp_ge_i32 s22, 10
    s_cselect_b32 s91, 1, 0
    s_cmp_lt_u32 s21, 4
    s_cbranch_scc1 L_compute
    s_sub_u32 s67, s21, 4
    s_mul_i32 s48, s19, 320
    s_add_u32 s48, s48, 1280
    s_and_b32 s57, s19, 1
    s_lshl_b32 s58, s57, 6
    s_add_u32 s58, s58, s48
    s_xor_b32 s57, s57, 1
    s_lshl_b32 s57, s57, 8
    s_add_u32 s57, s57, s48
    s_add_u32 s59, s58, 1280
    s_lshl_b32 s48, s22, 8
    s_lshl_b32 s49, s22, 7
    s_movk_i32 s56, 3072
    s_cmp_eq_u32 s20, 0
    s_cselect_b32 s68, 3840, s56
    s_cselect_b32 s60, s58, s48
    s_cselect_b32 s61, s59, s48
    s_cselect_b32 s62, 1, 0
    s_cselect_b32 s63, s57, s49
    s_cselect_b32 s64, 1280, 64
    s_cmp_lg_u32 s91, 0
    s_cselect_b32 s63, 2147418112, s63
    v_mov_b32 v29, 2147418112
    s_lshl_b32 s75, s68, 5
    s_lshl_b32 s69, s18, 2
    s_add_u32 s69, s69, s19
    v_and_b32 v3, 31, v2
    v_lshrrev_b32 v4, 5, v2
    s_movk_i32 s48, 3072
    s_cmp_eq_u32 s67, 1
    s_cselect_b32 s48, 3840, s48
    s_lshr_b32 s49, s48, 7
    s_lshl_b32 s85, s48, 6
    s_movk_i32 s56, 128
    s_cmp_eq_u32 s67, 0
    s_cselect_b32 s48, 40960, s48
    s_cselect_b32 s49, 32, s49
    s_cselect_b32 s85, 128, s85
    s_cselect_b32 s56, 1280, s56
    s_mul_i32 s48, s48, s69
    v_mul_u32_u24 v5, s56, v3
    v_mul_u32_u24 v6, s85, v4
    v_add3_u32 v5, v5, v6, s48
    v_cmp_gt_u32 vcc, s49, v3
    s_lshl_b32 s56, s20, 2
    s_lshr_b32 s56, 0x2100, s56
    s_and_b32 s56, s56, 15
    v_cndmask_b32 v30, v29, v5, vcc
    s_mul_i32 s56, s56, s85
    s_mov_b32 s26, 2621440
    s_mov_b32 s27, 0x20000
    s_mov_b32 s31, 0x20000
    s_mov_b32 s35, 0x20000
    s_mov_b32 s39, 0x20000
    s_mov_b32 s83, 0x20000
    s_mov_b32 s48, 1966080
    s_mov_b32 s38, 2457600
    s_cmp_eq_u32 s20, 0
    s_cselect_b32 s30, s38, s48
    s_mov_b32 s34, s30
    v_mov_b32 v38, 159744
    v_lshl_add_u32 v39, v2, 2, v38
    v_mov_b32 v44, 0
    s_lshl_b32 s71, s67, 8
    ds_write_b32 v39, v44
    v_add_u32 v39, s71, v39
    ds_write_b32 v39, v44 offset:256
    v_and_b32 v39, 3, v2
    v_lshlrev_b32 v39, 8, v39
    v_add_u32 v39, 160000, v39
    s_lshl_b32 s71, s67, 2
    s_add_u32 s71, s71, 159744
    s_cmp_eq_u32 s20, 0
    s_waitcnt lgkmcnt(0)
    s_mov_b32 s24, s4
    s_mov_b32 s25, s5
    s_mov_b32 s36, s6
    s_mov_b32 s37, s7
    s_cselect_b32 s28, s6, s8
    s_cselect_b32 s29, s7, s9
    s_cselect_b32 s32, s6, s10
    s_cselect_b32 s33, s7, s11
    s_cmp_eq_u32 s67, 2
    s_cselect_b32 s80, s8, s10
    s_cselect_b32 s81, s9, s11
    s_cmp_eq_u32 s67, 1
    s_cselect_b32 s80, s6, s80
    s_cselect_b32 s81, s7, s81
    s_cselect_b32 s82, s38, s48
    s_cmp_eq_u32 s67, 0
    s_cselect_b32 s80, s4, s80
    s_cselect_b32 s81, s5, s81
    s_cselect_b32 s82, s26, s82
    s_mov_b32 s97, s56
    s_cmp_eq_u32 s20, 0
    s_cbranch_scc1 L_nor0
    s_mov_b32 exec_hi, 0
    buffer_load_dword v36, v30, s[80:83], s56 offen
    s_mov_b32 exec_hi, -1
L_nor0:
    s_barrier
    s_cmp_eq_u32 s55, 0
    s_cbranch_scc1 L_nogw0
    s_mov_b32 s44, s14
    s_mov_b32 s45, s15
    s_mov_b32 s46, 1280
    s_mov_b32 s47, 0x20000
    v_lshlrev_b32 v40, 1, v2
    buffer_load_ushort v50, v40, s[44:47], 0 offen offset:0
    buffer_load_ushort v51, v40, s[44:47], 0 offen offset:128
    buffer_load_ushort v52, v40, s[44:47], 0 offen offset:256
    buffer_load_ushort v53, v40, s[44:47], 0 offen offset:384
    buffer_load_ushort v54, v40, s[44:47], 0 offen offset:512
    buffer_load_ushort v55, v40, s[44:47], 0 offen offset:640
    buffer_load_ushort v56, v40, s[44:47], 0 offen offset:768
    buffer_load_ushort v57, v40, s[44:47], 0 offen offset:896
    buffer_load_ushort v58, v40, s[44:47], 0 offen offset:1024
    buffer_load_ushort v59, v40, s[44:47], 0 offen offset:1152
L_nogw0:
    v_lshrrev_b32 v3, 3, v2
    v_and_b32 v4, 7, v2
    s_lshl_b32 s48, s18, 7
    s_lshl_b32 s56, s67, 5
    s_add_u32 s48, s48, s56
    v_add_u32 v7, s48, v3
    v_mul_u32_u24 v7, 1280, v7
    v_lshrrev_b32 v8, 4, v2
    v_xor_b32 v8, v8, v4
    v_lshl_add_u32 v16, v8, 4, v7
    v_xor_b32 v8, 4, v8
    v_lshl_add_u32 v17, v8, 4, v7
    v_add_u32 v17, 10240, v17
    v_add_u32 v18, 20480, v16
    v_add_u32 v19, 20480, v17
    s_lshl_b32 s56, s67, 3
    v_add_u32 v5, s56, v3
    s_and_b32 s56, s67, 1
    s_lshl_b32 s56, s56, 2
    v_and_b32 v6, 2, v3
    v_xor_b32 v6, v6, v4
    v_xor_b32 v6, s56, v6
    v_mul_u32_u24 v7, s68, v5
    v_lshl_add_u32 v8, v6, 4, v7
    v_add_u32 v10, s60, v8
    v_add_u32 v11, 128, v10
    v_xor_b32 v9, s62, v6
    v_lshl_add_u32 v8, v9, 4, v7
    v_add_u32 v12, s61, v8
    v_add_u32 v13, 128, v12
    v_lshrrev_b32 v8, 2, v6
    v_and_b32 v9, s62, v8
    v_and_b32 v6, 3, v6
    v_xor_b32 v6, v6, v9
    v_mul_u32_u24 v7, 3840, v5
    v_lshl_add_u32 v7, v6, 4, v7
    v_mul_u32_u24 v8, s64, v8
    v_add3_u32 v14, v7, v8, s63
    s_mov_b32 s76, 122880
    s_mov_b32 s70, 0
    s_mov_b32 s72, 0
    s_mov_b32 s74, 0
    s_mul_i32 s77, s67, 5120
    s_add_u32 s77, s77, 49152
    s_lshl_b32 s78, s67, 12
    s_add_u32 m0, s78, 0
    s_nop 0
    buffer_load_dwordx4 v16, s[24:27], s74 offen lds
    s_add_u32 m0, s78, 1024
    s_nop 0
    buffer_load_dwordx4 v17, s[24:27], s74 offen lds
    s_add_u32 m0, s78, 2048
    s_nop 0
    buffer_load_dwordx4 v18, s[24:27], s74 offen lds
    s_add_u32 m0, s78, 3072
    s_nop 0
    buffer_load_dwordx4 v19, s[24:27], s74 offen lds
    s_add_u32 s74, s74, 128
    s_add_u32 s78, s78, 16384
    s_cmp_ge_u32 s78, 49152
    s_cselect_b32 s48, 49152, 0
    s_sub_u32 s78, s78, s48
    s_add_u32 m0, s77, 0
    s_nop 0
    buffer_load_dwordx4 v10, s[28:31], s70 offen lds
    s_add_u32 m0, s77, 1024
    s_nop 0
    buffer_load_dwordx4 v11, s[28:31], s70 offen lds
    s_add_u32 m0, s77, 2048
    s_nop 0
    buffer_load_dwordx4 v12, s[32:35], s70 offen lds
    s_add_u32 m0, s77, 3072
    s_nop 0
    buffer_load_dwordx4 v13, s[32:35], s70 offen lds
    s_add_u32 m0, s77, 4096
    s_nop 0
    buffer_load_dwordx4 v14, s[36:39], s72 offen lds
    s_add_u32 s70, s70, s75
    s_add_u32 s72, s72, s76
    s_add_u32 s77, s77, 20480
    s_cmp_ge_u32 s77, 151552
    s_cselect_b32 s48, 102400, 0
    s_sub_u32 s77, s77, s48
    s_load_dwordx2 s[86:87], s[0:1], 72
    s_cmp_eq_u32 s55, 0
    s_cbranch_scc1 L_nogw
    v_and_b32 v41, 3, v2
    v_lshlrev_b32 v41, 3, v41
    v_bfe_u32 v40, v2, 2, 1
    v_lshl_add_u32 v41, v40, 9, v41
    v_bfe_u32 v40, v2, 3, 2
    v_lshl_add_u32 v41, v40, 5, v41
    v_bfe_u32 v40, v2, 5, 1
    v_mul_u32_u24 v40, 320, v40
    v_add_u32 v41, v40, v41
    v_add_u32 v41, 151552, v41
    s_waitcnt vmcnt(9)
    v_lshl_or_b32 v80, v50, 16, v50
    v_mov_b32 v81, v80
    ds_write_b64 v41, v[80:81] offset:0
    v_lshl_or_b32 v82, v51, 16, v51
    v_mov_b32 v83, v82
    ds_write_b64 v41, v[82:83] offset:640
    v_lshl_or_b32 v84, v52, 16, v52
    v_mov_b32 v85, v84
    ds_write_b64 v41, v[84:85] offset:1280
    v_lshl_or_b32 v86, v53, 16, v53
    v_mov_b32 v87, v86
    ds_write_b64 v41, v[86:87] offset:1920
    v_lshl_or_b32 v88, v54, 16, v54
    v_mov_b32 v89, v88
    ds_write_b64 v41, v[88:89] offset:2560
    v_lshl_or_b32 v90, v55, 16, v55
    v_mov_b32 v91, v90
    ds_write_b64 v41, v[90:91] offset:3200
    v_lshl_or_b32 v92, v56, 16, v56
    v_mov_b32 v93, v92
    ds_write_b64 v41, v[92:93] offset:3840
    v_lshl_or_b32 v94, v57, 16, v57
    v_mov_b32 v95, v94
    ds_write_b64 v41, v[94:95] offset:4480
    v_lshl_or_b32 v96, v58, 16, v58
    v_mov_b32 v97, v96
    ds_write_b64 v41, v[96:97] offset:5120
    v_lshl_or_b32 v98, v59, 16, v59
    v_mov_b32 v99, v98
    ds_write_b64 v41, v[98:99] offset:5760
L_nogw:
    s_mov_b32 s40, s16
    s_mov_b32 s41, s17
    s_mov_b32 s42, 17825792
    s_mov_b32 s43, 0x20000
    s_mov_b32 s44, s12
    s_mov_b32 s45, s13
    s_mov_b32 s46, 1966080
    s_mov_b32 s47, 0x20000
    s_waitcnt lgkmcnt(0)
    s_lshl_b32 s48, s2, 2
    s_add_u32 s48, s48, s67
    s_cmp_lg_u32 s48, 0
    s_cbranch_scc1 L_noep
    s_memrealtime s[88:89]
    s_waitcnt lgkmcnt(0)
    s_or_b32 s88, s88, 1
    v_mov_b32 v42, s88
    v_mov_b32 v43, s89
    s_mov_b64 exec, 1
    global_store_dwordx2 v44, v[42:43], s[86:87] sc1
    s_mov_b64 exec, -1
L_noep:
    v_lshlrev_b32 v5, 4, v2
    v_lshlrev_b32 v6, 3, v2
    v_add_u32 v7, 4096, v5
    s_mov_b32 s56, 0x3a529478
    s_mov_b32 s57, 0xb16
    s_lshl_b32 s48, s22, 2
    s_lshr_b64 s[56:57], s[56:57], s48
    s_and_b32 s48, s56, 15
    s_lshl_b32 s48, s48, 4
    s_add_u32 s48, s48, s18
    s_sub_u32 s60, s48, 120
    s_lshl_b32 s60, s60, 2
    s_add_u32 s60, s60, s67
    s_lshl_b32 s92, s48, 1
    s_add_u32 s92, s92, s67
    s_cmp_lt_u32 s67, 2
    s_cselect_b32 s92, s92, 999
    s_cmp_lt_u32 s92, 240
    s_cselect_b32 s64, 1, 0
    s_cmp_lt_u32 s60, 256
    s_cselect_b32 s64, 2, s64
    s_mul_i32 s62, s92, 52429
    s_lshr_b32 s62, s62, 18
    s_mul_i32 s63, s62, 5
    s_sub_u32 s63, s92, s63
    s_mul_i32 s79, s62, 40960
    s_lshl_b32 s56, s63, 8
    s_add_u32 s79, s79, s56
    s_lshl_b32 s63, s63, 3
    s_mul_i32 s62, s62, 5
    s_lshl_b32 s92, s92, 3
    s_add_u32 s92, s92, 16390144
    s_lshl_b32 s93, s67, 12
    s_add_u32 s93, s93, 151552
    s_lshl_b32 s48, s60, 3
    s_add_u32 s48, s48, 16123904
    s_cmp_eq_u32 s64, 2
    s_cselect_b32 s92, s48, s92
    v_and_b32 v8, 2, v3
    v_xor_b32 v8, v8, v4
    v_mul_u32_u24 v9, 1280, v3
    v_lshl_add_u32 v20, v8, 4, v9
    v_xor_b32 v8, 4, v8
    v_lshl_add_u32 v21, v8, 4, v9
    v_add_u32 v21, 10240, v21
    v_add_u32 v22, 20480, v20
    v_add_u32 v23, 20480, v21
    v_lshrrev_b32 v8, 2, v2
    v_and_b32 v9, 3, v2
    v_lshlrev_b32 v8, 7, v8
    v_lshl_add_u32 v8, v9, 3, v8
    v_add_u32 v8, s93, v8
    v_bfe_u32 v9, v2, 3, 1
    v_lshrrev_b32 v28, 5, v2
    v_lshl_add_u32 v9, v28, 1, v9
    v_xor_b32 v28, 0, v9
    v_lshl_add_u32 v24, v28, 5, v8
    v_xor_b32 v28, 1, v9
    v_lshl_add_u32 v25, v28, 5, v8
    v_xor_b32 v28, 2, v9
    v_lshl_add_u32 v26, v28, 5, v8
    v_xor_b32 v28, 3, v9
    v_lshl_add_u32 v27, v28, 5, v8
    v_mul_u32_u24 v31, 1280, v2
    s_mov_b32 s94, 0
    s_mov_b32 s84, -1
    s_cmp_eq_u32 s20, 1
    s_cselect_b32 s84, 0xfff230, s84
    s_cmp_eq_u32 s20, 2
    s_cselect_b32 s84, 0xfff351, s84
    s_cmp_eq_u32 s20, 3
    s_cselect_b32 s84, 0xfff472, s84
    s_and_b32 s58, s84, 15
    s_getpc_b64 s[8:9]
L_pc_1:
    s_add_u32 s8, s8, L_table-L_pc_1
    s_addc_u32 s9, s9, 0
    s_movk_i32 s10, 128
    s_mov_b32 s11, 0x20000
    s_mov_b32 s65, 1
    s_mov_b32 s66, 0
    s_mov_b32 m0, s71
    s_lshl_b32 s48, s65, 2
    s_mov_b64 exec, 1
    buffer_load_dword v44, s[8:11], s48 offen offset:0 lds
    s_mov_b64 exec, -1
    s_add_u32 m0, s77, 0
    s_nop 0
    buffer_load_dwordx4 v10, s[28:31], s70 offen lds
    s_add_u32 m0, s77, 1024
    s_nop 0
    buffer_load_dwordx4 v11, s[28:31], s70 offen lds
    s_add_u32 m0, s77, 2048
    s_nop 0
    buffer_load_dwordx4 v12, s[32:35], s70 offen lds
    s_add_u32 m0, s77, 3072
    s_nop 0
    buffer_load_dwordx4 v13, s[32:35], s70 offen lds
    s_add_u32 m0, s77, 4096
    s_nop 0
    buffer_load_dwordx4 v14, s[36:39], s72 offen lds
    s_add_u32 s70, s70, s75
    s_add_u32 s72, s72, s76
    s_add_u32 s77, s77, 20480
    s_cmp_ge_u32 s77, 151552
    s_cselect_b32 s48, 102400, 0
    s_sub_u32 s77, s77, s48
    s_mov_b32 s65, 2
    s_mov_b32 m0, s71
    s_lshl_b32 s48, s65, 2
    s_mov_b64 exec, 1
    buffer_load_dword v44, s[8:11], s48 offen offset:0 lds
    s_mov_b64 exec, -1
    s_mov_b32 s65, 1
    v_mov_b32 v0, 159744
    s_and_b32 s18, s2, 7
    s_lshl_b32 s18, s18, 2
    s_lshr_b32 s48, s2, 6
    s_add_u32 s18, s18, s48
    s_bfe_u32 s19, s2, 0x30003
    s_mul_i32 s23, s19, 3
    s_lshr_b32 s23, s23, 1
    s_and_b32 s48, s18, 3
    s_mul_i32 s48, s48, 3
    s_add_u32 s23, s23, s48
    s_cmp_ge_u32 s23, 12
    s_cselect_b32 s48, 12, 0
    s_sub_u32 s23, s23, s48
    s_and_b32 s48, s2, 7
    s_mul_i32 s48, s48, 12
    s_lshr_b32 s48, s48, 3
    s_add_u32 s23, s23, s48
    s_cmp_ge_u32 s23, 12
    s_cselect_b32 s48, 12, 0
    s_sub_u32 s23, s23, s48
    s_mul_i32 s48, s67, 12
    s_mul_i32 s50, s19, 48
    s_add_u32 s50, s50, s48
    s_mul_i32 s50, s50, 5120
    s_add_u32 s50, s50, 9437184
    s_mul_i32 s51, s18, 68
    s_add_u32 s51, s51, s48
    s_lshl_b32 s51, s51, 12
    s_mul_i32 s52, s67, 5120
    s_mul_i32 s53, s67, 480
    s_mul_i32 s48, s19, 5
    s_lshr_b32 s48, s48, 2
    s_add_u32 s53, s53, 16390144
    v_lshrrev_b32 v8, 1, v2
    v_mul_u32_u24 v8, 40, v8
    v_and_b32 v9, 1, v2
    v_add_u32 v9, s48, v9
    v_lshrrev_b32 v9, 1, v9
    v_lshl_add_u32 v28, v9, 3, v8
    s_lshr_b32 s48, s18, 1
    s_lshl_b32 s54, s48, 13
    s_add_u32 s54, s54, 15990784
    s_mov_b32 s55, 16123904
    s_load_dwordx2 s[4:5], s[0:1], 16
    s_mov_b32 s6, 819200
    s_mov_b32 s7, 0x20000
    s_and_b32 s69, s2, 7
    s_lshl_b32 s69, s69, 3
    s_bfe_u32 s48, s2, 0x30003
    s_add_u32 s69, s69, s48
    s_lshr_b32 s48, s69, 2
    s_lshl_b32 s48, s48, 1
    s_and_b32 s49, s67, 1
    s_add_u32 s48, s48, s49
    s_mul_i32 s48, s48, 25600
    s_and_b32 s49, s69, 3
    s_lshl_b32 s49, s49, 1
    s_lshr_b32 s56, s67, 1
    s_add_u32 s49, s49, s56
    s_mul_i32 s49, s49, 160
    s_add_u32 s73, s48, s49
    v_add_u32 v58, 0, v2
    v_mul_u32_u24 v59, 6554, v58
    v_lshrrev_b32 v59, 16, v59
    v_mul_u32_u24 v60, 10, v59
    v_sub_u32 v60, v58, v60
    v_mul_u32_u24 v59, 1280, v59
    v_lshl_add_u32 v224, v60, 4, v59
    v_add_u32 v58, 64, v2
    v_mul_u32_u24 v59, 6554, v58
    v_lshrrev_b32 v59, 16, v59
    v_mul_u32_u24 v60, 10, v59
    v_sub_u32 v60, v58, v60
    v_mul_u32_u24 v59, 1280, v59
    v_lshl_add_u32 v225, v60, 4, v59
    v_add_u32 v58, 128, v2
    v_mul_u32_u24 v59, 6554, v58
    v_lshrrev_b32 v59, 16, v59
    v_mul_u32_u24 v60, 10, v59
    v_sub_u32 v60, v58, v60
    v_mul_u32_u24 v59, 1280, v59
    v_lshl_add_u32 v226, v60, 4, v59
    v_add_u32 v58, 192, v2
    v_mul_u32_u24 v59, 6554, v58
    v_lshrrev_b32 v59, 16, v59
    v_mul_u32_u24 v60, 10, v59
    v_sub_u32 v60, v58, v60
    v_mul_u32_u24 v59, 1280, v59
    v_lshl_add_u32 v227, v60, 4, v59
    v_add_u32 v58, 256, v2
    v_mul_u32_u24 v59, 6554, v58
    v_lshrrev_b32 v59, 16, v59
    v_mul_u32_u24 v60, 10, v59
    v_sub_u32 v60, v58, v60
    v_mul_u32_u24 v59, 1280, v59
    v_lshl_add_u32 v228, v60, 4, v59
    s_waitcnt lgkmcnt(0)
    s_branch L_ld_join
    .p2align 3
L_ld_loop:
    s_sub_u32 s57, s65, 4
    s_cmp_ge_i32 s66, s57
    s_cbranch_scc1 L_free_2
    s_mov_b32 s96, 0
L_lw_3:
    ds_read_b32 v48, v39
    s_waitcnt lgkmcnt(0)
    v_readlane_b32 s66, v48, 0
    v_readlane_b32 s48, v48, 1
    s_min_u32 s66, s66, s48
    v_readlane_b32 s48, v48, 2
    s_min_u32 s66, s66, s48
    v_readlane_b32 s48, v48, 3
    s_min_u32 s66, s66, s48
    s_cmp_ge_i32 s66, s57
    s_cbranch_scc1 L_lwd_4
    s_sleep 1
    s_add_u32 s96, s96, 1
    s_cmp_lt_u32 s96, 2097152
    s_cbranch_scc1 L_lw_3
L_lwd_4:
L_free_2:
    s_add_u32 m0, s78, 0
    s_nop 0
    buffer_load_dwordx4 v16, s[24:27], s74 offen lds
    s_add_u32 m0, s78, 1024
    s_nop 0
    buffer_load_dwordx4 v17, s[24:27], s74 offen lds
    s_add_u32 m0, s78, 2048
    s_nop 0
    buffer_load_dwordx4 v18, s[24:27], s74 offen lds
    s_add_u32 m0, s78, 3072
    s_nop 0
    buffer_load_dwordx4 v19, s[24:27], s74 offen lds
    s_add_u32 s74, s74, 128
    s_add_u32 s78, s78, 16384
    s_cmp_ge_u32 s78, 49152
    s_cselect_b32 s48, 49152, 0
    s_sub_u32 s78, s78, s48
    s_add_u32 m0, s77, 0
    s_nop 0
    buffer_load_dwordx4 v10, s[28:31], s70 offen lds
    s_add_u32 m0, s77, 1024
    s_nop 0
    buffer_load_dwordx4 v11, s[28:31], s70 offen lds
    s_add_u32 m0, s77, 2048
    s_nop 0
    buffer_load_dwordx4 v12, s[32:35], s70 offen lds
    s_add_u32 m0, s77, 3072
    s_nop 0
    buffer_load_dwordx4 v13, s[32:35], s70 offen lds
    s_add_u32 m0, s77, 4096
    s_nop 0
    buffer_load_dwordx4 v14, s[36:39], s72 offen lds
    s_add_u32 s70, s70, s75
    s_add_u32 s72, s72, s76
    s_add_u32 s77, s77, 20480
    s_cmp_ge_u32 s77, 151552
    s_cselect_b32 s48, 102400, 0
    s_sub_u32 s77, s77, s48
    s_add_u32 s65, s65, 1
    s_mov_b32 m0, s71
    s_lshl_b32 s48, s65, 2
    s_mov_b64 exec, 1
    buffer_load_dword v44, s[8:11], s48 offen offset:0 lds
    s_mov_b64 exec, -1
L_ld_odd:
    s_sub_u32 s57, s65, 4
    s_cmp_ge_i32 s66, s57
    s_cbranch_scc1 L_free_5
    s_mov_b32 s96, 0
L_lw_6:
    ds_read_b32 v48, v39
    s_waitcnt lgkmcnt(0)
    v_readlane_b32 s66, v48, 0
    v_readlane_b32 s48, v48, 1
    s_min_u32 s66, s66, s48
    v_readlane_b32 s48, v48, 2
    s_min_u32 s66, s66, s48
    v_readlane_b32 s48, v48, 3
    s_min_u32 s66, s66, s48
    s_cmp_ge_i32 s66, s57
    s_cbranch_scc1 L_lwd_7
    s_sleep 1
    s_add_u32 s96, s96, 1
    s_cmp_lt_u32 s96, 2097152
    s_cbranch_scc1 L_lw_6
L_lwd_7:
L_free_5:
    s_add_u32 m0, s77, 0
    s_nop 0
    buffer_load_dwordx4 v10, s[28:31], s70 offen lds
    s_add_u32 m0, s77, 1024
    s_nop 0
    buffer_load_dwordx4 v11, s[28:31], s70 offen lds
    s_add_u32 m0, s77, 2048
    s_nop 0
    buffer_load_dwordx4 v12, s[32:35], s70 offen lds
    s_add_u32 m0, s77, 3072
    s_nop 0
    buffer_load_dwordx4 v13, s[32:35], s70 offen lds
    s_add_u32 m0, s77, 4096
    s_nop 0
    buffer_load_dwordx4 v14, s[36:39], s72 offen lds
    s_add_u32 s70, s70, s75
    s_add_u32 s72, s72, s76
    s_add_u32 s77, s77, 20480
    s_cmp_ge_u32 s77, 151552
    s_cselect_b32 s48, 102400, 0
    s_sub_u32 s77, s77, s48
L_ld_join:
    s_lshr_b32 s49, s65, 1
    s_add_u32 s65, s65, 1
    s_mov_b32 m0, s71
    s_lshl_b32 s48, s65, 2
    s_mov_b64 exec, 1
    buffer_load_dword v44, s[8:11], s48 offen offset:0 lds
    s_mov_b64 exec, -1
    s_cmp_eq_u32 s49, s58
    s_cbranch_scc1 L_ev_round
L_ev_r1:
    s_cmp_lg_u32 s65, 18
    s_cbranch_scc1 L_ev_r2
    global_load_dwordx2 v[56:57], v44, s[86:87] sc1
    s_mov_b64 exec, 0xffffff
    buffer_load_dwordx2 v[46:47], v28, s[40:43], s53 offen sc1
    s_mov_b64 exec, -1
    s_cmp_lg_u32 s67, 1
    s_cbranch_scc1 L_ci_8
    buffer_load_dwordx4 v[96:99], v5, s[40:43], s55 offen sc1
    buffer_load_dwordx4 v[100:103], v5, s[40:43], s55 offen offset:1024 sc1
L_ci_8:
L_ev_r2:
    s_cmp_lt_u32 s65, 20
    s_cbranch_scc1 L_ld_loop
    s_branch L_ld_done
L_ev_round:
    s_add_u32 s58, s58, 1
    s_add_u32 s94, s94, 1
    s_cmp_eq_u32 s94, 2
    s_cbranch_scc1 L_ev_s1
    s_cmp_eq_u32 s94, 3
    s_cbranch_scc1 L_ev_s2
    s_cmp_eq_u32 s94, 4
    s_cbranch_scc1 L_ev_flag
    s_bfe_u32 s59, s84, 0x40004
    s_mul_i32 s56, s85, s59
    buffer_load_dword v36, v30, s[80:83], s56 offen
    s_cmp_lg_u32 s59, 5
    s_cbranch_scc1 L_ev_no3
    s_mul_i32 s56, s85, 9
    s_mov_b32 exec_hi, 0
    buffer_load_dword v37, v30, s[80:83], s56 offen
    s_mov_b32 exec_hi, -1
L_ev_no3:
    s_cmp_eq_u32 s64, 0
    s_cselect_b32 s58, 15, s58
    s_cbranch_scc1 L_ev_r1
    global_load_dwordx2 v[42:43], v44, s[86:87] sc1
    s_cmp_eq_u32 s64, 2
    s_cbranch_scc1 L_ev_poison
    s_mov_b32 exec_hi, 0
    buffer_load_dword v37, v31, s[44:47], s79 offen offset:128
    s_mov_b32 exec_hi, -1
L_ev_dma:
    s_add_u32 m0, s93, 0
    s_nop 0
    buffer_load_dwordx4 v20, s[44:47], s79 offen lds
    s_add_u32 m0, s93, 1024
    s_nop 0
    buffer_load_dwordx4 v21, s[44:47], s79 offen lds
    s_add_u32 m0, s93, 2048
    s_nop 0
    buffer_load_dwordx4 v22, s[44:47], s79 offen lds
    s_add_u32 m0, s93, 3072
    s_nop 0
    buffer_load_dwordx4 v23, s[44:47], s79 offen lds
    s_add_u32 s79, s79, 128
    s_branch L_ev_r1
L_ev_s1:
    s_waitcnt vmcnt(16)
    ds_read_b64_tr_b16 v[64:65], v24
    ds_read_b64_tr_b16 v[66:67], v24 offset:2048
    ds_read_b64_tr_b16 v[68:69], v25
    ds_read_b64_tr_b16 v[70:71], v25 offset:2048
    ds_read_b64_tr_b16 v[72:73], v26
    ds_read_b64_tr_b16 v[74:75], v26 offset:2048
    ds_read_b64_tr_b16 v[76:77], v27
    ds_read_b64_tr_b16 v[78:79], v27 offset:2048
    s_waitcnt lgkmcnt(0)
    s_branch L_ev_dma
L_ev_s2:
    s_waitcnt vmcnt(16)
    ds_read_b64_tr_b16 v[80:81], v24
    ds_read_b64_tr_b16 v[82:83], v24 offset:2048
    ds_read_b64_tr_b16 v[84:85], v25
    ds_read_b64_tr_b16 v[86:87], v25 offset:2048
    ds_read_b64_tr_b16 v[88:89], v26
    ds_read_b64_tr_b16 v[90:91], v26 offset:2048
    ds_read_b64_tr_b16 v[92:93], v27
    ds_read_b64_tr_b16 v[94:95], v27 offset:2048
    s_waitcnt lgkmcnt(0)
    s_add_u32 s56, s63, 0
    s_mul_i32 s57, s56, 52429
    s_lshr_b32 s57, s57, 18
    s_mul_i32 s57, s57, 235
    s_add_u32 s57, s57, s56
    s_add_u32 s57, s57, s62
    s_lshl_b32 s57, s57, 10
    s_add_u32 s57, s57, 9437184
    buffer_store_dwordx4 v[64:67], v5, s[40:43], s57 offen sc1
    s_add_u32 s56, s63, 1
    s_mul_i32 s57, s56, 52429
    s_lshr_b32 s57, s57, 18
    s_mul_i32 s57, s57, 235
    s_add_u32 s57, s57, s56
    s_add_u32 s57, s57, s62
    s_lshl_b32 s57, s57, 10
    s_add_u32 s57, s57, 9437184
    buffer_store_dwordx4 v[68:71], v5, s[40:43], s57 offen sc1
    s_add_u32 s56, s63, 2
    s_mul_i32 s57, s56, 52429
    s_lshr_b32 s57, s57, 18
    s_mul_i32 s57, s57, 235
    s_add_u32 s57, s57, s56
    s_add_u32 s57, s57, s62
    s_lshl_b32 s57, s57, 10
    s_add_u32 s57, s57, 9437184
    buffer_store_dwordx4 v[72:75], v5, s[40:43], s57 offen sc1
    s_add_u32 s56, s63, 3
    s_mul_i32 s57, s56, 52429
    s_lshr_b32 s57, s57, 18
    s_mul_i32 s57, s57, 235
    s_add_u32 s57, s57, s56
    s_add_u32 s57, s57, s62
    s_lshl_b32 s57, s57, 10
    s_add_u32 s57, s57, 9437184
    buffer_store_dwordx4 v[76:79], v5, s[40:43], s57 offen sc1
    s_add_u32 s56, s63, 4
    s_mul_i32 s57, s56, 52429
    s_lshr_b32 s57, s57, 18
    s_mul_i32 s57, s57, 235
    s_add_u32 s57, s57, s56
    s_add_u32 s57, s57, s62
    s_lshl_b32 s57, s57, 10
    s_add_u32 s57, s57, 9437184
    buffer_store_dwordx4 v[80:83], v5, s[40:43], s57 offen sc1
    s_add_u32 s56, s63, 5
    s_mul_i32 s57, s56, 52429
    s_lshr_b32 s57, s57, 18
    s_mul_i32 s57, s57, 235
    s_add_u32 s57, s57, s56
    s_add_u32 s57, s57, s62
    s_lshl_b32 s57, s57, 10
    s_add_u32 s57, s57, 9437184
    buffer_store_dwordx4 v[84:87], v5, s[40:43], s57 offen sc1
    s_add_u32 s56, s63, 6
    s_mul_i32 s57, s56, 52429
    s_lshr_b32 s57, s57, 18
    s_mul_i32 s57, s57, 235
    s_add_u32 s57, s57, s56
    s_add_u32 s57, s57, s62
    s_lshl_b32 s57, s57, 10
    s_add_u32 s57, s57, 9437184
    buffer_store_dwordx4 v[88:91], v5, s[40:43], s57 offen sc1
    s_add_u32 s56, s63, 7
    s_mul_i32 s57, s56, 52429
    s_lshr_b32 s57, s57, 18
    s_mul_i32 s57, s57, 235
    s_add_u32 s57, s57, s56
    s_add_u32 s57, s57, s62
    s_lshl_b32 s57, s57, 10
    s_add_u32 s57, s57, 9437184
    buffer_store_dwordx4 v[92:95], v5, s[40:43], s57 offen sc1
    s_branch L_ev_r1
L_ev_poison:
    s_mov_b32 s94, 3
    v_mov_b32 v64, -1
    v_mov_b32 v65, -1
    v_mov_b32 v66, -1
    v_mov_b32 v67, -1
    s_mul_i32 s56, s60, 3200
    s_add_u32 s56, s56, 11534336
    s_lshl_b32 s57, s60, 7
    s_add_u32 s57, s57, 15794176
    s_cmp_lt_u32 s60, 128
    s_cselect_b32 s57, s57, 2147418112
    buffer_store_dwordx4 v[64:67], v5, s[40:43], s56 offen offset:0 sc1
    buffer_store_dwordx4 v[64:67], v5, s[40:43], s56 offen offset:1024 sc1
    buffer_store_dwordx4 v[64:67], v5, s[40:43], s56 offen offset:2048 sc1
    s_mov_b64 exec, 0xff
    buffer_store_dwordx4 v[64:67], v5, s[40:43], s56 offen offset:3072 sc1
    buffer_store_dwordx4 v[64:67], v5, s[40:43], s57 offen sc1
    s_mov_b64 exec, -1
L_ev_rw:
    s_branch L_ev_r1
L_ev_flag:
    s_movk_i32 s58, 15
    s_mov_b32 s90, 0
    s_waitcnt vmcnt(15)
L_ep_9:
    v_readfirstlane_b32 s88, v42
    s_cmp_lg_u32 s88, 0
    s_cbranch_scc1 L_epok_10
    s_sleep 4
    global_load_dwordx2 v[42:43], v44, s[86:87] sc1
    s_waitcnt vmcnt(0)
    s_add_u32 s90, s90, 1
    s_cmp_lt_u32 s90, 131072
    s_cbranch_scc1 L_ep_9
L_epok_10:
    s_mov_b64 exec, 1
    buffer_store_dwordx2 v[42:43], v44, s[40:43], s92 offen sc1
    s_mov_b64 exec, -1
    s_branch L_ev_r1
L_ld_done:
    s_mov_b32 s90, 0
    s_waitcnt vmcnt(16)
L_b_chk:
    v_readfirstlane_b32 s88, v56
    v_readfirstlane_b32 s89, v57
    s_nop 1
    s_mov_b64 exec, 0xffffff
    v_cmp_ne_u64 s[60:61], s[88:89], v[46:47]
    s_mov_b64 exec, -1
    s_cmp_lg_u32 s67, 1
    s_cbranch_scc1 L_ce_11
    v_cmp_ne_u64 vcc, s[88:89], v[96:97]
    s_or_b64 s[60:61], s[60:61], vcc
    v_cmp_ne_u64 vcc, s[88:89], v[98:99]
    s_or_b64 s[60:61], s[60:61], vcc
    v_cmp_ne_u64 vcc, s[88:89], v[100:101]
    s_or_b64 s[60:61], s[60:61], vcc
    v_cmp_ne_u64 vcc, s[88:89], v[102:103]
    s_or_b64 s[60:61], s[60:61], vcc
L_ce_11:
    s_cmp_eq_u32 s88, 0
    s_cselect_b32 s60, 1, s60
    s_cmp_eq_u64 s[60:61], 0
    s_cbranch_scc1 L_b_chkok
    s_sleep 16
    global_load_dwordx2 v[56:57], v44, s[86:87] sc1
    s_mov_b64 exec, 0xffffff
    buffer_load_dwordx2 v[46:47], v28, s[40:43], s53 offen sc1
    s_mov_b64 exec, -1
    s_cmp_lg_u32 s67, 1
    s_cbranch_scc1 L_ci_12
    buffer_load_dwordx4 v[96:99], v5, s[40:43], s55 offen sc1
    buffer_load_dwordx4 v[100:103], v5, s[40:43], s55 offen offset:1024 sc1
L_ci_12:
    s_waitcnt vmcnt(0)
    s_add_u32 s90, s90, 1
    s_cmp_lt_u32 s90, 131072
    s_cbranch_scc1 L_b_chk
L_b_chkok:
    s_cmp_lg_u32 s67, 1
    s_cbranch_scc1 L_b_nofp
    v_mov_b32 v46, 1
    s_mov_b64 exec, 1
    ds_write_b64 v0, v[56:57] offset:32
    ds_write_b32 v0, v46 offset:72
    s_mov_b64 exec, -1
L_b_nofp:
    s_cmp_eq_u32 s20, 0
    s_cbranch_scc1 L_b_kv
    s_add_u32 s56, s23, 0
    s_cmp_ge_u32 s56, 12
    s_cselect_b32 s48, 12, 0
    s_sub_u32 s56, s56, s48
    s_mul_i32 s56, s56, 5120
    s_add_u32 s56, s56, s50
    s_waitcnt vmcnt(6)
    buffer_load_dwordx4 v[104:107], v5, s[40:43], s56 offen offset:0 sc1
    buffer_load_dwordx4 v[108:111], v5, s[40:43], s56 offen offset:1024 sc1
    buffer_load_dwordx4 v[112:115], v5, s[40:43], s56 offen offset:2048 sc1
    buffer_load_dwordx4 v[116:119], v5, s[40:43], s56 offen offset:3072 sc1
    buffer_load_dwordx4 v[120:123], v7, s[40:43], s56 offen offset:0 sc1
    s_add_u32 s56, s23, 1
    s_cmp_ge_u32 s56, 12
    s_cselect_b32 s48, 12, 0
    s_sub_u32 s56, s56, s48
    s_mul_i32 s56, s56, 5120
    s_add_u32 s56, s56, s50
    s_waitcnt vmcnt(6)
    buffer_load_dwordx4 v[124:127], v5, s[40:43], s56 offen offset:0 sc1
    buffer_load_dwordx4 v[128:131], v5, s[40:43], s56 offen offset:1024 sc1
    buffer_load_dwordx4 v[132:135], v5, s[40:43], s56 offen offset:2048 sc1
    buffer_load_dwordx4 v[136:139], v5, s[40:43], s56 offen offset:3072 sc1
    buffer_load_dwordx4 v[140:143], v7, s[40:43], s56 offen offset:0 sc1
    s_add_u32 s56, s23, 2
    s_cmp_ge_u32 s56, 12
    s_cselect_b32 s48, 12, 0
    s_sub_u32 s56, s56, s48
    s_mul_i32 s56, s56, 5120
    s_add_u32 s56, s56, s50
    s_waitcnt vmcnt(6)
    buffer_load_dwordx4 v[144:147], v5, s[40:43], s56 offen offset:0 sc1
    buffer_load_dwordx4 v[148:151], v5, s[40:43], s56 offen offset:1024 sc1
    buffer_load_dwordx4 v[152:155], v5, s[40:43], s56 offen offset:2048 sc1
    buffer_load_dwordx4 v[156:159], v5, s[40:43], s56 offen offset:3072 sc1
    buffer_load_dwordx4 v[160:163], v7, s[40:43], s56 offen offset:0 sc1
    s_add_u32 s56, s23, 9
    s_cmp_ge_u32 s56, 12
    s_cselect_b32 s48, 12, 0
    s_sub_u32 s56, s56, s48
    s_mul_i32 s56, s56, 5120
    s_add_u32 s56, s56, s50
    s_waitcnt vmcnt(6)
    buffer_load_dwordx4 v[164:167], v5, s[40:43], s56 offen offset:0 sc1
    buffer_load_dwordx4 v[168:171], v5, s[40:43], s56 offen offset:1024 sc1
    buffer_load_dwordx4 v[172:175], v5, s[40:43], s56 offen offset:2048 sc1
    buffer_load_dwordx4 v[176:179], v5, s[40:43], s56 offen offset:3072 sc1
    buffer_load_dwordx4 v[180:183], v7, s[40:43], s56 offen offset:0 sc1
    s_add_u32 s56, s23, 10
    s_cmp_ge_u32 s56, 12
    s_cselect_b32 s48, 12, 0
    s_sub_u32 s56, s56, s48
    s_mul_i32 s56, s56, 5120
    s_add_u32 s56, s56, s50
    s_waitcnt vmcnt(6)
    buffer_load_dwordx4 v[184:187], v5, s[40:43], s56 offen offset:0 sc1
    buffer_load_dwordx4 v[188:191], v5, s[40:43], s56 offen offset:1024 sc1
    buffer_load_dwordx4 v[192:195], v5, s[40:43], s56 offen offset:2048 sc1
    buffer_load_dwordx4 v[196:199], v5, s[40:43], s56 offen offset:3072 sc1
    buffer_load_dwordx4 v[200:203], v7, s[40:43], s56 offen offset:0 sc1
    s_add_u32 s56, s23, 11
    s_cmp_ge_u32 s56, 12
    s_cselect_b32 s48, 12, 0
    s_sub_u32 s56, s56, s48
    s_mul_i32 s56, s56, 5120
    s_add_u32 s56, s56, s50
    s_waitcnt vmcnt(6)
    buffer_load_dwordx4 v[204:207], v5, s[40:43], s56 offen offset:0 sc1
    buffer_load_dwordx4 v[208:211], v5, s[40:43], s56 offen offset:1024 sc1
    buffer_load_dwordx4 v[212:215], v5, s[40:43], s56 offen offset:2048 sc1
    buffer_load_dwordx4 v[216:219], v5, s[40:43], s56 offen offset:3072 sc1
    buffer_load_dwordx4 v[220:223], v7, s[40:43], s56 offen offset:0 sc1
    s_mov_b32 s96, 0
L_lw_13:
    ds_read_b32 v48, v39
    s_waitcnt lgkmcnt(0)
    v_readlane_b32 s90, v48, 0
    v_readlane_b32 s48, v48, 1
    s_min_u32 s90, s90, s48
    v_readlane_b32 s48, v48, 2
    s_min_u32 s90, s90, s48
    v_readlane_b32 s48, v48, 3
    s_min_u32 s90, s90, s48
    s_cmp_ge_i32 s90, 20
    s_cbranch_scc1 L_lwd_14
    s_sleep 1
    s_add_u32 s96, s96, 1
    s_cmp_lt_u32 s96, 2097152
    s_cbranch_scc1 L_lw_13
L_lwd_14:
    s_mov_b32 s96, 0
L_lw_15:
    ds_read_b128 v[48:51], v38 offset:48
    s_waitcnt lgkmcnt(0)
    v_min3_u32 v48, v48, v49, v50
    v_min_u32 v48, v48, v51
    s_nop 0
    v_readfirstlane_b32 s90, v48
    s_cmp_ge_i32 s90, 1
    s_cbranch_scc1 L_lwd_16
    s_sleep 4
    s_add_u32 s96, s96, 1
    s_cmp_lt_u32 s96, 2097152
    s_cbranch_scc1 L_lw_15
L_lwd_16:
    s_add_u32 s56, s23, 3
    s_cmp_ge_u32 s56, 12
    s_cselect_b32 s48, 12, 0
    s_sub_u32 s56, s56, s48
    s_mul_i32 s56, s56, 5120
    s_add_u32 s56, s56, s50
    s_add_u32 m0, s52, 49152
    s_waitcnt vmcnt(6)
    buffer_load_dwordx4 v5, s[40:43], s56 offen offset:0 sc1 lds
    buffer_load_dwordx4 v5, s[40:43], s56 offen offset:1024 sc1 lds
    buffer_load_dwordx4 v5, s[40:43], s56 offen offset:2048 sc1 lds
    buffer_load_dwordx4 v5, s[40:43], s56 offen offset:3072 sc1 lds
    s_add_u32 m0, s52, 53248
    s_nop 0
    buffer_load_dwordx4 v7, s[40:43], s56 offen sc1 lds
    s_add_u32 s56, s23, 4
    s_cmp_ge_u32 s56, 12
    s_cselect_b32 s48, 12, 0
    s_sub_u32 s56, s56, s48
    s_mul_i32 s56, s56, 5120
    s_add_u32 s56, s56, s50
    s_add_u32 m0, s52, 69632
    s_waitcnt vmcnt(6)
    buffer_load_dwordx4 v5, s[40:43], s56 offen offset:0 sc1 lds
    buffer_load_dwordx4 v5, s[40:43], s56 offen offset:1024 sc1 lds
    buffer_load_dwordx4 v5, s[40:43], s56 offen offset:2048 sc1 lds
    buffer_load_dwordx4 v5, s[40:43], s56 offen offset:3072 sc1 lds
    s_add_u32 m0, s52, 73728
    s_nop 0
    buffer_load_dwordx4 v7, s[40:43], s56 offen sc1 lds
    s_add_u32 s56, s23, 5
    s_cmp_ge_u32 s56, 12
    s_cselect_b32 s48, 12, 0
    s_sub_u32 s56, s56, s48
    s_mul_i32 s56, s56, 5120
    s_add_u32 s56, s56, s50
    s_add_u32 m0, s52, 90112
    s_waitcnt vmcnt(6)
    buffer_load_dwordx4 v5, s[40:43], s56 offen offset:0 sc1 lds
    buffer_load_dwordx4 v5, s[40:43], s56 offen offset:1024 sc1 lds
    buffer_load_dwordx4 v5, s[40:43], s56 offen offset:2048 sc1 lds
    buffer_load_dwordx4 v5, s[40:43], s56 offen offset:3072 sc1 lds
    s_add_u32 m0, s52, 94208
    s_nop 0
    buffer_load_dwordx4 v7, s[40:43], s56 offen sc1 lds
    s_add_u32 s56, s23, 6
    s_cmp_ge_u32 s56, 12
    s_cselect_b32 s48, 12, 0
    s_sub_u32 s56, s56, s48
    s_mul_i32 s56, s56, 5120
    s_add_u32 s56, s56, s50
    s_add_u32 m0, s52, 110592
    s_waitcnt vmcnt(6)
    buffer_load_dwordx4 v5, s[40:43], s56 offen offset:0 sc1 lds
    buffer_load_dwordx4 v5, s[40:43], s56 offen offset:1024 sc1 lds
    buffer_load_dwordx4 v5, s[40:43], s56 offen offset:2048 sc1 lds
    buffer_load_dwordx4 v5, s[40:43], s56 offen offset:3072 sc1 lds
    s_add_u32 m0, s52, 114688
    s_nop 0
    buffer_load_dwordx4 v7, s[40:43], s56 offen sc1 lds
    s_add_u32 s56, s23, 7
    s_cmp_ge_u32 s56, 12
    s_cselect_b32 s48, 12, 0
    s_sub_u32 s56, s56, s48
    s_mul_i32 s56, s56, 5120
    s_add_u32 s56, s56, s50
    s_add_u32 m0, s52, 20480
    s_waitcnt vmcnt(6)
    buffer_load_dwordx4 v5, s[40:43], s56 offen offset:0 sc1 lds
    buffer_load_dwordx4 v5, s[40:43], s56 offen offset:1024 sc1 lds
    buffer_load_dwordx4 v5, s[40:43], s56 offen offset:2048 sc1 lds
    buffer_load_dwordx4 v5, s[40:43], s56 offen offset:3072 sc1 lds
    s_add_u32 m0, s52, 24576
    s_nop 0
    buffer_load_dwordx4 v7, s[40:43], s56 offen sc1 lds
    s_add_u32 s56, s23, 8
    s_cmp_ge_u32 s56, 12
    s_cselect_b32 s48, 12, 0
    s_sub_u32 s56, s56, s48
    s_mul_i32 s56, s56, 5120
    s_add_u32 s56, s56, s50
    s_add_u32 m0, s52, 131072
    s_waitcnt vmcnt(6)
    buffer_load_dwordx4 v5, s[40:43], s56 offen offset:0 sc1 lds
    buffer_load_dwordx4 v5, s[40:43], s56 offen offset:1024 sc1 lds
    buffer_load_dwordx4 v5, s[40:43], s56 offen offset:2048 sc1 lds
    buffer_load_dwordx4 v5, s[40:43], s56 offen offset:3072 sc1 lds
    s_add_u32 m0, s52, 135168
    s_nop 0
    buffer_load_dwordx4 v7, s[40:43], s56 offen sc1 lds
    s_branch L_b_common
L_b_kv:
    s_add_u32 s56, s23, 0
    s_cmp_ge_u32 s56, 12
    s_cselect_b32 s48, 12, 0
    s_sub_u32 s56, s56, s48
    s_mul_i32 s56, s56, 5120
    s_add_u32 s56, s56, s50
    s_waitcnt vmcnt(6)
    buffer_load_dwordx4 v[104:107], v5, s[40:43], s56 offen offset:0 sc1
    buffer_load_dwordx4 v[108:111], v5, s[40:43], s56 offen offset:1024 sc1
    buffer_load_dwordx4 v[112:115], v5, s[40:43], s56 offen offset:2048 sc1
    buffer_load_dwordx4 v[116:119], v5, s[40:43], s56 offen offset:3072 sc1
    buffer_load_dwordx4 v[120:123], v7, s[40:43], s56 offen offset:0 sc1
    s_mov_b32 s96, 0
L_lw_17:
    ds_read_b32 v48, v39
    s_waitcnt lgkmcnt(0)
    v_readlane_b32 s90, v48, 0
    v_readlane_b32 s48, v48, 1
    s_min_u32 s90, s90, s48
    v_readlane_b32 s48, v48, 2
    s_min_u32 s90, s90, s48
    v_readlane_b32 s48, v48, 3
    s_min_u32 s90, s90, s48
    s_cmp_ge_i32 s90, 16
    s_cbranch_scc1 L_lwd_18
    s_sleep 1
    s_add_u32 s96, s96, 1
    s_cmp_lt_u32 s96, 2097152
    s_cbranch_scc1 L_lw_17
L_lwd_18:
    s_add_u32 s56, s23, 3
    s_cmp_ge_u32 s56, 12
    s_cselect_b32 s48, 12, 0
    s_sub_u32 s56, s56, s48
    s_mul_i32 s56, s56, 5120
    s_add_u32 s56, s56, s50
    s_add_u32 m0, s52, 49152
    s_waitcnt vmcnt(6)
    buffer_load_dwordx4 v5, s[40:43], s56 offen offset:0 sc1 lds
    buffer_load_dwordx4 v5, s[40:43], s56 offen offset:1024 sc1 lds
    buffer_load_dwordx4 v5, s[40:43], s56 offen offset:2048 sc1 lds
    buffer_load_dwordx4 v5, s[40:43], s56 offen offset:3072 sc1 lds
    s_add_u32 m0, s52, 53248
    s_nop 0
    buffer_load_dwordx4 v7, s[40:43], s56 offen sc1 lds
    s_mov_b32 s96, 0
L_lw_19:
    ds_read_b32 v48, v39
    s_waitcnt lgkmcnt(0)
    v_readlane_b32 s90, v48, 0
    v_readlane_b32 s48, v48, 1
    s_min_u32 s90, s90, s48
    v_readlane_b32 s48, v48, 2
    s_min_u32 s90, s90, s48
    v_readlane_b32 s48, v48, 3
    s_min_u32 s90, s90, s48
    s_cmp_ge_i32 s90, 17
    s_cbranch_scc1 L_lwd_20
    s_sleep 1
    s_add_u32 s96, s96, 1
    s_cmp_lt_u32 s96, 2097152
    s_cbranch_scc1 L_lw_19
L_lwd_20:
    s_add_u32 s56, s23, 4
    s_cmp_ge_u32 s56, 12
    s_cselect_b32 s48, 12, 0
    s_sub_u32 s56, s56, s48
    s_mul_i32 s56, s56, 5120
    s_add_u32 s56, s56, s50
    s_add_u32 m0, s52, 69632
    s_waitcnt vmcnt(6)
    buffer_load_dwordx4 v5, s[40:43], s56 offen offset:0 sc1 lds
    buffer_load_dwordx4 v5, s[40:43], s56 offen offset:1024 sc1 lds
    buffer_load_dwordx4 v5, s[40:43], s56 offen offset:2048 sc1 lds
    buffer_load_dwordx4 v5, s[40:43], s56 offen offset:3072 sc1 lds
    s_add_u32 m0, s52, 73728
    s_nop 0
    buffer_load_dwordx4 v7, s[40:43], s56 offen sc1 lds
    s_mov_b32 s96, 0
L_lw_21:
    ds_read_b32 v48, v39
    s_waitcnt lgkmcnt(0)
    v_readlane_b32 s90, v48, 0
    v_readlane_b32 s48, v48, 1
    s_min_u32 s90, s90, s48
    v_readlane_b32 s48, v48, 2
    s_min_u32 s90, s90, s48
    v_readlane_b32 s48, v48, 3
    s_min_u32 s90, s90, s48
    s_cmp_ge_i32 s90, 18
    s_cbranch_scc1 L_lwd_22
    s_sleep 1
    s_add_u32 s96, s96, 1
    s_cmp_lt_u32 s96, 2097152
    s_cbranch_scc1 L_lw_21
L_lwd_22:
    s_add_u32 s56, s23, 5
    s_cmp_ge_u32 s56, 12
    s_cselect_b32 s48, 12, 0
    s_sub_u32 s56, s56, s48
    s_mul_i32 s56, s56, 5120
    s_add_u32 s56, s56, s50
    s_add_u32 m0, s52, 90112
    s_waitcnt vmcnt(6)
    buffer_load_dwordx4 v5, s[40:43], s56 offen offset:0 sc1 lds
    buffer_load_dwordx4 v5, s[40:43], s56 offen offset:1024 sc1 lds
    buffer_load_dwordx4 v5, s[40:43], s56 offen offset:2048 sc1 lds
    buffer_load_dwordx4 v5, s[40:43], s56 offen offset:3072 sc1 lds
    s_add_u32 m0, s52, 94208
    s_nop 0
    buffer_load_dwordx4 v7, s[40:43], s56 offen sc1 lds
    s_mov_b32 s96, 0
L_lw_23:
    ds_read_b32 v48, v39
    s_waitcnt lgkmcnt(0)
    v_readlane_b32 s90, v48, 0
    v_readlane_b32 s48, v48, 1
    s_min_u32 s90, s90, s48
    v_readlane_b32 s48, v48, 2
    s_min_u32 s90, s90, s48
    v_readlane_b32 s48, v48, 3
    s_min_u32 s90, s90, s48
    s_cmp_ge_i32 s90, 18
    s_cbranch_scc1 L_lwd_24
    s_sleep 1
    s_add_u32 s96, s96, 1
    s_cmp_lt_u32 s96, 2097152
    s_cbranch_scc1 L_lw_23
L_lwd_24:
    s_add_u32 s56, s23, 7
    s_cmp_ge_u32 s56, 12
    s_cselect_b32 s48, 12, 0
    s_sub_u32 s56, s56, s48
    s_mul_i32 s56, s56, 5120
    s_add_u32 s56, s56, s50
    s_add_u32 m0, s52, 20480
    s_waitcnt vmcnt(6)
    buffer_load_dwordx4 v5, s[40:43], s56 offen offset:0 sc1 lds
    buffer_load_dwordx4 v5, s[40:43], s56 offen offset:1024 sc1 lds
    buffer_load_dwordx4 v5, s[40:43], s56 offen offset:2048 sc1 lds
    buffer_load_dwordx4 v5, s[40:43], s56 offen offset:3072 sc1 lds
    s_add_u32 m0, s52, 24576
    s_nop 0
    buffer_load_dwordx4 v7, s[40:43], s56 offen sc1 lds
    s_mov_b32 s96, 0
L_lw_25:
    ds_read_b32 v48, v39
    s_waitcnt lgkmcnt(0)
    v_readlane_b32 s90, v48, 0
    v_readlane_b32 s48, v48, 1
    s_min_u32 s90, s90, s48
    v_readlane_b32 s48, v48, 2
    s_min_u32 s90, s90, s48
    v_readlane_b32 s48, v48, 3
    s_min_u32 s90, s90, s48
    s_cmp_ge_i32 s90, 19
    s_cbranch_scc1 L_lwd_26
    s_sleep 1
    s_add_u32 s96, s96, 1
    s_cmp_lt_u32 s96, 2097152
    s_cbranch_scc1 L_lw_25
L_lwd_26:
    s_add_u32 s56, s23, 6
    s_cmp_ge_u32 s56, 12
    s_cselect_b32 s48, 12, 0
    s_sub_u32 s56, s56, s48
    s_mul_i32 s56, s56, 5120
    s_add_u32 s56, s56, s50
    s_add_u32 m0, s52, 110592
    s_waitcnt vmcnt(6)
    buffer_load_dwordx4 v5, s[40:43], s56 offen offset:0 sc1 lds
    buffer_load_dwordx4 v5, s[40:43], s56 offen offset:1024 sc1 lds
    buffer_load_dwordx4 v5, s[40:43], s56 offen offset:2048 sc1 lds
    buffer_load_dwordx4 v5, s[40:43], s56 offen offset:3072 sc1 lds
    s_add_u32 m0, s52, 114688
    s_nop 0
    buffer_load_dwordx4 v7, s[40:43], s56 offen sc1 lds
    s_mov_b32 s96, 0
L_lw_27:
    ds_read_b32 v48, v39
    s_waitcnt lgkmcnt(0)
    v_readlane_b32 s90, v48, 0
    v_readlane_b32 s48, v48, 1
    s_min_u32 s90, s90, s48
    v_readlane_b32 s48, v48, 2
    s_min_u32 s90, s90, s48
    v_readlane_b32 s48, v48, 3
    s_min_u32 s90, s90, s48
    s_cmp_ge_i32 s90, 20
    s_cbranch_scc1 L_lwd_28
    s_sleep 1
    s_add_u32 s96, s96, 1
    s_cmp_lt_u32 s96, 2097152
    s_cbranch_scc1 L_lw_27
L_lwd_28:
    s_add_u32 m0, s52, 0
    s_nop 0
    buffer_load_dwordx4 v224, s[4:7], s73 offen lds
    s_add_u32 m0, s52, 1024
    s_nop 0
    buffer_load_dwordx4 v225, s[4:7], s73 offen lds
    s_add_u32 m0, s52, 2048
    s_nop 0
    buffer_load_dwordx4 v226, s[4:7], s73 offen lds
    s_add_u32 m0, s52, 3072
    s_nop 0
    buffer_load_dwordx4 v227, s[4:7], s73 offen lds
    s_add_u32 m0, s52, 4096
    s_nop 0
    buffer_load_dwordx4 v228, s[4:7], s73 offen lds
    s_lshl_b32 s48, s67, 2
    s_add_u32 m0, s48, 159856
    s_mov_b64 exec, 1
    buffer_load_dword v44, s[8:11], 4 offen lds
    s_mov_b64 exec, -1
    s_add_u32 s56, s23, 8
    s_cmp_ge_u32 s56, 12
    s_cselect_b32 s48, 12, 0
    s_sub_u32 s56, s56, s48
    s_mul_i32 s56, s56, 5120
    s_add_u32 s56, s56, s50
    s_add_u32 m0, s52, 131072
    s_waitcnt vmcnt(6)
    buffer_load_dwordx4 v5, s[40:43], s56 offen offset:0 sc1 lds
    buffer_load_dwordx4 v5, s[40:43], s56 offen offset:1024 sc1 lds
    buffer_load_dwordx4 v5, s[40:43], s56 offen offset:2048 sc1 lds
    buffer_load_dwordx4 v5, s[40:43], s56 offen offset:3072 sc1 lds
    s_add_u32 m0, s52, 135168
    s_nop 0
    buffer_load_dwordx4 v7, s[40:43], s56 offen sc1 lds
    ds_read_b32 v48, v39
    s_waitcnt lgkmcnt(0)
    v_readlane_b32 s90, v48, 0
    v_readlane_b32 s48, v48, 1
    s_min_u32 s90, s90, s48
    v_readlane_b32 s48, v48, 2
    s_min_u32 s90, s90, s48
    v_readlane_b32 s48, v48, 3
    s_min_u32 s90, s90, s48
    s_cmp_lt_i32 s90, 21
    s_cbranch_scc1 L_ps_29
    s_mov_b32 s96, 0
L_lw_30:
    ds_read_b32 v48, v39
    s_waitcnt lgkmcnt(0)
    v_readlane_b32 s90, v48, 0
    v_readlane_b32 s48, v48, 1
    s_min_u32 s90, s90, s48
    v_readlane_b32 s48, v48, 2
    s_min_u32 s90, s90, s48
    v_readlane_b32 s48, v48, 3
    s_min_u32 s90, s90, s48
    s_cmp_ge_i32 s90, 22
    s_cbranch_scc1 L_lwd_31
    s_sleep 2
    s_add_u32 s96, s96, 1
    s_cmp_lt_u32 s96, 2097152
    s_cbranch_scc1 L_lw_30
L_lwd_31:
L_ps_29:
    s_add_u32 s56, s23, 1
    s_cmp_ge_u32 s56, 12
    s_cselect_b32 s48, 12, 0
    s_sub_u32 s56, s56, s48
    s_mul_i32 s56, s56, 5120
    s_add_u32 s56, s56, s50
    s_waitcnt vmcnt(6)
    buffer_load_dwordx4 v[124:127], v5, s[40:43], s56 offen offset:0 sc1
    buffer_load_dwordx4 v[128:131], v5, s[40:43], s56 offen offset:1024 sc1
    buffer_load_dwordx4 v[132:135], v5, s[40:43], s56 offen offset:2048 sc1
    buffer_load_dwordx4 v[136:139], v5, s[40:43], s56 offen offset:3072 sc1
    buffer_load_dwordx4 v[140:143], v7, s[40:43], s56 offen offset:0 sc1
    ds_read_b32 v48, v39
    s_waitcnt lgkmcnt(0)
    v_readlane_b32 s90, v48, 0
    v_readlane_b32 s48, v48, 1
    s_min_u32 s90, s90, s48
    v_readlane_b32 s48, v48, 2
    s_min_u32 s90, s90, s48
    v_readlane_b32 s48, v48, 3
    s_min_u32 s90, s90, s48
    s_cmp_lt_i32 s90, 21
    s_cbranch_scc1 L_ps_32
    s_mov_b32 s96, 0
L_lw_33:
    ds_read_b32 v48, v39
    s_waitcnt lgkmcnt(0)
    v_readlane_b32 s90, v48, 0
    v_readlane_b32 s48, v48, 1
    s_min_u32 s90, s90, s48
    v_readlane_b32 s48, v48, 2
    s_min_u32 s90, s90, s48
    v_readlane_b32 s48, v48, 3
    s_min_u32 s90, s90, s48
    s_cmp_ge_i32 s90, 22
    s_cbranch_scc1 L_lwd_34
    s_sleep 2
    s_add_u32 s96, s96, 1
    s_cmp_lt_u32 s96, 2097152
    s_cbranch_scc1 L_lw_33
L_lwd_34:
L_ps_32:
    s_add_u32 s56, s23, 2
    s_cmp_ge_u32 s56, 12
    s_cselect_b32 s48, 12, 0
    s_sub_u32 s56, s56, s48
    s_mul_i32 s56, s56, 5120
    s_add_u32 s56, s56, s50
    s_waitcnt vmcnt(6)
    buffer_load_dwordx4 v[144:147], v5, s[40:43], s56 offen offset:0 sc1
    buffer_load_dwordx4 v[148:151], v5, s[40:43], s56 offen offset:1024 sc1
    buffer_load_dwordx4 v[152:155], v5, s[40:43], s56 offen offset:2048 sc1
    buffer_load_dwordx4 v[156:159], v5, s[40:43], s56 offen offset:3072 sc1
    buffer_load_dwordx4 v[160:163], v7, s[40:43], s56 offen offset:0 sc1
    ds_read_b32 v48, v39
    s_waitcnt lgkmcnt(0)
    v_readlane_b32 s90, v48, 0
    v_readlane_b32 s48, v48, 1
    s_min_u32 s90, s90, s48
    v_readlane_b32 s48, v48, 2
    s_min_u32 s90, s90, s48
    v_readlane_b32 s48, v48, 3
    s_min_u32 s90, s90, s48
    s_cmp_lt_i32 s90, 21
    s_cbranch_scc1 L_ps_35
    s_mov_b32 s96, 0
L_lw_36:
    ds_read_b32 v48, v39
    s_waitcnt lgkmcnt(0)
    v_readlane_b32 s90, v48, 0
    v_readlane_b32 s48, v48, 1
    s_min_u32 s90, s90, s48
    v_readlane_b32 s48, v48, 2
    s_min_u32 s90, s90, s48
    v_readlane_b32 s48, v48, 3
    s_min_u32 s90, s90, s48
    s_cmp_ge_i32 s90, 22
    s_cbranch_scc1 L_lwd_37
    s_sleep 2
    s_add_u32 s96, s96, 1
    s_cmp_lt_u32 s96, 2097152
    s_cbranch_scc1 L_lw_36
L_lwd_37:
L_ps_35:
    s_add_u32 s56, s23, 9
    s_cmp_ge_u32 s56, 12
    s_cselect_b32 s48, 12, 0
    s_sub_u32 s56, s56, s48
    s_mul_i32 s56, s56, 5120
    s_add_u32 s56, s56, s50
    s_waitcnt vmcnt(6)
    buffer_load_dwordx4 v[164:167], v5, s[40:43], s56 offen offset:0 sc1
    buffer_load_dwordx4 v[168:171], v5, s[40:43], s56 offen offset:1024 sc1
    buffer_load_dwordx4 v[172:175], v5, s[40:43], s56 offen offset:2048 sc1
    buffer_load_dwordx4 v[176:179], v5, s[40:43], s56 offen offset:3072 sc1
    buffer_load_dwordx4 v[180:183], v7, s[40:43], s56 offen offset:0 sc1
    ds_read_b32 v48, v39
    s_waitcnt lgkmcnt(0)
    v_readlane_b32 s90, v48, 0
    v_readlane_b32 s48, v48, 1
    s_min_u32 s90, s90, s48
    v_readlane_b32 s48, v48, 2
    s_min_u32 s90, s90, s48
    v_readlane_b32 s48, v48, 3
    s_min_u32 s90, s90, s48
    s_cmp_lt_i32 s90, 21
    s_cbranch_scc1 L_ps_38
    s_mov_b32 s96, 0
L_lw_39:
    ds_read_b32 v48, v39
    s_waitcnt lgkmcnt(0)
    v_readlane_b32 s90, v48, 0
    v_readlane_b32 s48, v48, 1
    s_min_u32 s90, s90, s48
    v_readlane_b32 s48, v48, 2
    s_min_u32 s90, s90, s48
    v_readlane_b32 s48, v48, 3
    s_min_u32 s90, s90, s48
    s_cmp_ge_i32 s90, 22
    s_cbranch_scc1 L_lwd_40
    s_sleep 2
    s_add_u32 s96, s96, 1
    s_cmp_lt_u32 s96, 2097152
    s_cbranch_scc1 L_lw_39
L_lwd_40:
L_ps_38:
    s_add_u32 s56, s23, 10
    s_cmp_ge_u32 s56, 12
    s_cselect_b32 s48, 12, 0
    s_sub_u32 s56, s56, s48
    s_mul_i32 s56, s56, 5120
    s_add_u32 s56, s56, s50
    s_waitcnt vmcnt(6)
    buffer_load_dwordx4 v[184:187], v5, s[40:43], s56 offen offset:0 sc1
    buffer_load_dwordx4 v[188:191], v5, s[40:43], s56 offen offset:1024 sc1
    buffer_load_dwordx4 v[192:195], v5, s[40:43], s56 offen offset:2048 sc1
    buffer_load_dwordx4 v[196:199], v5, s[40:43], s56 offen offset:3072 sc1
    buffer_load_dwordx4 v[200:203], v7, s[40:43], s56 offen offset:0 sc1
    ds_read_b32 v48, v39
    s_waitcnt lgkmcnt(0)
    v_readlane_b32 s90, v48, 0
    v_readlane_b32 s48, v48, 1
    s_min_u32 s90, s90, s48
    v_readlane_b32 s48, v48, 2
    s_min_u32 s90, s90, s48
    v_readlane_b32 s48, v48, 3
    s_min_u32 s90, s90, s48
    s_cmp_lt_i32 s90, 21
    s_cbranch_scc1 L_ps_41
    s_mov_b32 s96, 0
L_lw_42:
    ds_read_b32 v48, v39
    s_waitcnt lgkmcnt(0)
    v_readlane_b32 s90, v48, 0
    v_readlane_b32 s48, v48, 1
    s_min_u32 s90, s90, s48
    v_readlane_b32 s48, v48, 2
    s_min_u32 s90, s90, s48
    v_readlane_b32 s48, v48, 3
    s_min_u32 s90, s90, s48
    s_cmp_ge_i32 s90, 22
    s_cbranch_scc1 L_lwd_43
    s_sleep 2
    s_add_u32 s96, s96, 1
    s_cmp_lt_u32 s96, 2097152
    s_cbranch_scc1 L_lw_42
L_lwd_43:
L_ps_41:
    s_add_u32 s56, s23, 11
    s_cmp_ge_u32 s56, 12
    s_cselect_b32 s48, 12, 0
    s_sub_u32 s56, s56, s48
    s_mul_i32 s56, s56, 5120
    s_add_u32 s56, s56, s50
    s_waitcnt vmcnt(6)
    buffer_load_dwordx4 v[204:207], v5, s[40:43], s56 offen offset:0 sc1
    buffer_load_dwordx4 v[208:211], v5, s[40:43], s56 offen offset:1024 sc1
    buffer_load_dwordx4 v[212:215], v5, s[40:43], s56 offen offset:2048 sc1
    buffer_load_dwordx4 v[216:219], v5, s[40:43], s56 offen offset:3072 sc1
    buffer_load_dwordx4 v[220:223], v7, s[40:43], s56 offen offset:0 sc1
    s_mov_b32 s96, 0
L_lw_44:
    ds_read_b128 v[48:51], v0 offset:80
    s_waitcnt lgkmcnt(0)
    v_min3_u32 v48, v48, v49, v50
    v_min_u32 v48, v48, v51
    s_nop 0
    v_readfirstlane_b32 s90, v48
    s_cmp_ge_i32 s90, 1
    s_cbranch_scc1 L_lwd_45
    s_sleep 4
    s_add_u32 s96, s96, 1
    s_cmp_lt_u32 s96, 2097152
    s_cbranch_scc1 L_lw_44
L_lwd_45:
    s_cmp_lg_u32 s67, 3
    s_cbranch_scc1 L_b_common
    s_mov_b32 s96, 0
    s_mov_b32 s75, 0
L_gp_46:
    s_mov_b32 exec_hi, 0xffff
    buffer_load_dwordx2 v[46:47], v6, s[40:43], s54 offen sc1
    s_waitcnt vmcnt(0)
    v_cmp_ne_u64 vcc, s[88:89], v[46:47]
    s_mov_b32 exec_hi, -1
    s_mov_b32 s74, 0
    s_bfe_u64 s[76:77], vcc, 0xc0000
    s_cselect_b32 s48, 0, 1
    s_or_b32 s74, s74, s48
    s_bfe_u64 s[76:77], vcc, 0xc000c
    s_cselect_b32 s48, 0, 2
    s_or_b32 s74, s74, s48
    s_bfe_u64 s[76:77], vcc, 0xc0018
    s_cselect_b32 s48, 0, 4
    s_or_b32 s74, s74, s48
    s_bfe_u64 s[76:77], vcc, 0xc0024
    s_cselect_b32 s48, 0, 8
    s_or_b32 s74, s74, s48
    s_cmp_eq_u32 s74, s75
    s_cbranch_scc1 L_gs_47
    s_mov_b32 s75, s74
    v_mov_b32 v46, s74
    s_mov_b64 exec, 1
    ds_write_b32 v0, v46 offset:64
    s_mov_b64 exec, -1
L_gs_47:
    s_cmp_eq_u32 s74, 15
    s_cbranch_scc1 L_gd_48
    s_sleep 8
    s_add_u32 s96, s96, 1
    s_cmp_lt_u32 s96, 131072
    s_cbranch_scc1 L_gp_46
L_gd_48:
L_b_common:
    v_add_u32 v8, s52, v5
    v_add_u32 v9, 90112, v8
    v_add_u32 v12, 69632, v8
    s_load_dwordx2 s[28:29], s[0:1], 64
    s_mov_b32 s30, 2621440
    s_mov_b32 s31, 0x20000
    s_lshl_b32 s48, s67, 2
    v_add_u32 v13, s48, v0
    v_mov_b32 v14, 1
    s_mul_i32 s48, s67, 20480
    s_add_u32 s48, s48, 49152
    v_add_u32 v15, s48, v5
    s_mul_i32 s48, s67, 15360
    s_cmp_eq_u32 s67, 3
    s_cselect_b32 s48, 131072, s48
    v_add_u32 v16, s48, v5
    s_lshl_b32 s48, s67, 11
    s_add_u32 s48, s48, 146432
    v_add_u32 v17, s48, v5
    s_lshl_b32 s48, s67, 8
    v_lshlrev_b32 v19, 2, v2
    v_add_u32 v19, s48, v19
    s_lshl_b32 s48, s18, 6
    s_lshl_b32 s49, s67, 4
    s_add_u32 s48, s48, s49
    v_and_b32 v20, 15, v2
    v_add_u32 v20, s48, v20
    v_mul_u32_u24 v20, 1280, v20
    v_lshrrev_b32 v21, 4, v2
    v_lshl_add_u32 v20, v21, 3, v20
    s_mul_i32 s55, s19, 160
    s_mul_i32 s48, s67, 5
    s_mul_i32 s57, s18, 68
    s_add_u32 s57, s57, s48
    s_add_u32 s57, s57, 48
    s_lshl_b32 s57, s57, 12
    s_lshl_b32 s58, s18, 8
    s_add_u32 s58, s58, 15728640
    v_and_b32 v3, 15, v2
    v_lshlrev_b32 v11, 2, v3
    s_mul_i32 s48, s67, 320
    s_add_u32 s48, s48, 161280
    v_mul_u32_u24 v4, 80, v21
    v_add_u32 v4, s48, v4
    v_lshrrev_b32 v10, 2, v3
    v_cmp_eq_u32 s[64:65], v10, v21
    v_and_b32 v10, 1, v3
    v_cmp_eq_u32 s[62:63], 0, v10
    s_and_b64 s[60:61], s[64:65], s[62:63]
    s_andn2_b64 s[62:63], s[64:65], s[62:63]
    s_mov_b32 s64, 897988541
    s_mov_b32 s65, 0xffff0000
    s_setprio 0
    s_lshl_b32 s59, 1, s67
    s_mov_b32 s96, 0
L_mw_49:
    ds_read_b32 v10, v0 offset:64
    s_waitcnt lgkmcnt(0)
    v_readfirstlane_b32 s90, v10
    s_andn2_b32 s90, s59, s90
    s_cbranch_scc0 L_mwd_50
    s_sleep 2
    s_add_u32 s96, s96, 1
    s_cmp_lt_u32 s96, 2097152
    s_cbranch_scc1 L_mw_49
L_mwd_50:
    s_waitcnt vmcnt(0)
    s_add_u32 s56, s23, 0
    s_cmp_ge_u32 s56, 12
    s_cselect_b32 s48, 12, 0
    s_sub_u32 s56, s56, s48
    s_lshl_b32 s56, s56, 12
    s_add_u32 s56, s56, s51
    buffer_load_dwordx4 v[224:227], v5, s[40:43], s56 offen offset:0 sc1
    buffer_load_dwordx4 v[228:231], v5, s[40:43], s56 offen offset:1024 sc1
    buffer_load_dwordx4 v[232:235], v5, s[40:43], s56 offen offset:2048 sc1
    buffer_load_dwordx4 v[236:239], v5, s[40:43], s56 offen offset:3072 sc1
    s_add_u32 s56, s23, 1
    s_cmp_ge_u32 s56, 12
    s_cselect_b32 s48, 12, 0
    s_sub_u32 s56, s56, s48
    s_lshl_b32 s56, s56, 12
    s_add_u32 s56, s56, s51
    buffer_load_dwordx4 v[240:243], v5, s[40:43], s56 offen offset:0 sc1
    buffer_load_dwordx4 v[244:247], v5, s[40:43], s56 offen offset:1024 sc1
    buffer_load_dwordx4 v[248:251], v5, s[40:43], s56 offen offset:2048 sc1
    buffer_load_dwordx4 v[252:255], v5, s[40:43], s56 offen offset:3072 sc1
    s_waitcnt vmcnt(7)
    v_mfma_f32_16x16x32_bf16 v[24:27], v[104:107], v[224:227], 0
    s_add_u32 s56, s23, 2
    s_cmp_ge_u32 s56, 12
    v_mfma_f32_16x16x32_bf16 v[28:31], v[108:111], v[224:227], 0
    s_cselect_b32 s48, 12, 0
    s_sub_u32 s56, s56, s48
    v_mfma_f32_16x16x32_bf16 v[32:35], v[112:115], v[224:227], 0
    s_lshl_b32 s56, s56, 12
    s_add_u32 s56, s56, s51
    v_mfma_f32_16x16x32_bf16 v[36:39], v[116:119], v[224:227], 0
    v_mfma_f32_16x16x32_bf16 v[40:43], v[120:123], v[224:227], 0
    buffer_load_dwordx4 v[224:227], v5, s[40:43], s56 offen offset:0 sc1
    s_waitcnt vmcnt(7)
    v_mfma_f32_16x16x32_bf16 v[44:47], v[104:107], v[228:231], 0
    v_mfma_f32_16x16x32_bf16 v[48:51], v[108:111], v[228:231], 0
    v_mfma_f32_16x16x32_bf16 v[52:55], v[112:115], v[228:231], 0
    v_mfma_f32_16x16x32_bf16 v[56:59], v[116:119], v[228:231], 0
    v_mfma_f32_16x16x32_bf16 v[60:63], v[120:123], v[228:231], 0
    buffer_load_dwordx4 v[228:231], v5, s[40:43], s56 offen offset:1024 sc1
    s_waitcnt vmcnt(7)
    v_mfma_f32_16x16x32_bf16 v[64:67], v[104:107], v[232:235], 0
    v_mfma_f32_16x16x32_bf16 v[68:71], v[108:111], v[232:235], 0
    v_mfma_f32_16x16x32_bf16 v[72:75], v[112:115], v[232:235], 0
    v_mfma_f32_16x16x32_bf16 v[76:79], v[116:119], v[232:235], 0
    v_mfma_f32_16x16x32_bf16 v[80:83], v[120:123], v[232:235], 0
    buffer_load_dwordx4 v[232:235], v5, s[40:43], s56 offen offset:2048 sc1
    s_waitcnt vmcnt(7)
    v_mfma_f32_16x16x32_bf16 v[84:87], v[104:107], v[236:239], 0
    v_mfma_f32_16x16x32_bf16 v[88:91], v[108:111], v[236:239], 0
    v_mfma_f32_16x16x32_bf16 v[92:95], v[112:115], v[236:239], 0
    v_mfma_f32_16x16x32_bf16 v[96:99], v[116:119], v[236:239], 0
    v_mfma_f32_16x16x32_bf16 v[100:103], v[120:123], v[236:239], 0
    buffer_load_dwordx4 v[236:239], v5, s[40:43], s56 offen offset:3072 sc1
    s_waitcnt vmcnt(7)
    v_mfma_f32_16x16x32_bf16 v[24:27], v[124:127], v[240:243], v[24:27]
    s_add_u32 s56, s23, 3
    s_cmp_ge_u32 s56, 12
    v_mfma_f32_16x16x32_bf16 v[28:31], v[128:131], v[240:243], v[28:31]
    ds_read_b128 v[104:107], v8 offset:49152
    s_cselect_b32 s48, 12, 0
    s_sub_u32 s56, s56, s48
    v_mfma_f32_16x16x32_bf16 v[32:35], v[132:135], v[240:243], v[32:35]
    s_lshl_b32 s56, s56, 12
    s_add_u32 s56, s56, s51
    v_mfma_f32_16x16x32_bf16 v[36:39], v[136:139], v[240:243], v[36:39]
    ds_read_b128 v[108:111], v8 offset:50176
    v_mfma_f32_16x16x32_bf16 v[40:43], v[140:143], v[240:243], v[40:43]
    buffer_load_dwordx4 v[240:243], v5, s[40:43], s56 offen offset:0 sc1
    s_waitcnt vmcnt(7)
    v_mfma_f32_16x16x32_bf16 v[44:47], v[124:127], v[244:247], v[44:47]
    v_mfma_f32_16x16x32_bf16 v[48:51], v[128:131], v[244:247], v[48:51]
    ds_read_b128 v[112:115], v8 offset:51200
    v_mfma_f32_16x16x32_bf16 v[52:55], v[132:135], v[244:247], v[52:55]
    v_mfma_f32_16x16x32_bf16 v[56:59], v[136:139], v[244:247], v[56:59]
    ds_read_b128 v[116:119], v8 offset:52224
    v_mfma_f32_16x16x32_bf16 v[60:63], v[140:143], v[244:247], v[60:63]
    buffer_load_dwordx4 v[244:247], v5, s[40:43], s56 offen offset:1024 sc1
    s_waitcnt vmcnt(7)
    v_mfma_f32_16x16x32_bf16 v[64:67], v[124:127], v[248:251], v[64:67]
    v_mfma_f32_16x16x32_bf16 v[68:71], v[128:131], v[248:251], v[68:71]
    ds_read_b128 v[120:123], v8 offset:53248
    v_mfma_f32_16x16x32_bf16 v[72:75], v[132:135], v[248:251], v[72:75]
    v_mfma_f32_16x16x32_bf16 v[76:79], v[136:139], v[248:251], v[76:79]
    v_mfma_f32_16x16x32_bf16 v[80:83], v[140:143], v[248:251], v[80:83]
    buffer_load_dwordx4 v[248:251], v5, s[40:43], s56 offen offset:2048 sc1
    s_waitcnt vmcnt(7)
    v_mfma_f32_16x16x32_bf16 v[84:87], v[124:127], v[252:255], v[84:87]
    v_mfma_f32_16x16x32_bf16 v[88:91], v[128:131], v[252:255], v[88:91]
    v_mfma_f32_16x16x32_bf16 v[92:95], v[132:135], v[252:255], v[92:95]
    v_mfma_f32_16x16x32_bf16 v[96:99], v[136:139], v[252:255], v[96:99]
    v_mfma_f32_16x16x32_bf16 v[100:103], v[140:143], v[252:255], v[100:103]
    buffer_load_dwordx4 v[252:255], v5, s[40:43], s56 offen offset:3072 sc1
    s_waitcnt vmcnt(7)
    v_mfma_f32_16x16x32_bf16 v[24:27], v[144:147], v[224:227], v[24:27]
    s_add_u32 s56, s23, 4
    s_cmp_ge_u32 s56, 12
    v_mfma_f32_16x16x32_bf16 v[28:31], v[148:151], v[224:227], v[28:31]
    s_cselect_b32 s48, 12, 0
    s_sub_u32 s56, s56, s48
    v_mfma_f32_16x16x32_bf16 v[32:35], v[152:155], v[224:227], v[32:35]
    s_lshl_b32 s56, s56, 12
    s_add_u32 s56, s56, s51
    v_mfma_f32_16x16x32_bf16 v[36:39], v[156:159], v[224:227], v[36:39]
    v_mfma_f32_16x16x32_bf16 v[40:43], v[160:163], v[224:227], v[40:43]
    buffer_load_dwordx4 v[224:227], v5, s[40:43], s56 offen offset:0 sc1
    s_waitcnt vmcnt(7)
    v_mfma_f32_16x16x32_bf16 v[44:47], v[144:147], v[228:231], v[44:47]
    v_mfma_f32_16x16x32_bf16 v[48:51], v[148:151], v[228:231], v[48:51]
    v_mfma_f32_16x16x32_bf16 v[52:55], v[152:155], v[228:231], v[52:55]
    v_mfma_f32_16x16x32_bf16 v[56:59], v[156:159], v[228:231], v[56:59]
    v_mfma_f32_16x16x32_bf16 v[60:63], v[160:163], v[228:231], v[60:63]
    buffer_load_dwordx4 v[228:231], v5, s[40:43], s56 offen offset:1024 sc1
    s_waitcnt vmcnt(7)
    v_mfma_f32_16x16x32_bf16 v[64:67], v[144:147], v[232:235], v[64:67]
    v_mfma_f32_16x16x32_bf16 v[68:71], v[148:151], v[232:235], v[68:71]
    v_mfma_f32_16x16x32_bf16 v[72:75], v[152:155], v[232:235], v[72:75]
    v_mfma_f32_16x16x32_bf16 v[76:79], v[156:159], v[232:235], v[76:79]
    v_mfma_f32_16x16x32_bf16 v[80:83], v[160:163], v[232:235], v[80:83]
    buffer_load_dwordx4 v[232:235], v5, s[40:43], s56 offen offset:2048 sc1
    s_waitcnt vmcnt(7)
    v_mfma_f32_16x16x32_bf16 v[84:87], v[144:147], v[236:239], v[84:87]
    v_mfma_f32_16x16x32_bf16 v[88:91], v[148:151], v[236:239], v[88:91]
    v_mfma_f32_16x16x32_bf16 v[92:95], v[152:155], v[236:239], v[92:95]
    v_mfma_f32_16x16x32_bf16 v[96:99], v[156:159], v[236:239], v[96:99]
    v_mfma_f32_16x16x32_bf16 v[100:103], v[160:163], v[236:239], v[100:103]
    buffer_load_dwordx4 v[236:239], v5, s[40:43], s56 offen offset:3072 sc1
    s_add_u32 s56, s23, 5
    s_cmp_ge_u32 s56, 12
    s_cselect_b32 s48, 12, 0
    s_sub_u32 s56, s56, s48
    s_lshl_b32 s56, s56, 12
    s_add_u32 s56, s56, s51
    buffer_load_dwordx4 v[144:147], v5, s[40:43], s56 offen offset:0 sc1
    buffer_load_dwordx4 v[148:151], v5, s[40:43], s56 offen offset:1024 sc1
    buffer_load_dwordx4 v[152:155], v5, s[40:43], s56 offen offset:2048 sc1
    buffer_load_dwordx4 v[156:159], v5, s[40:43], s56 offen offset:3072 sc1
    s_waitcnt vmcnt(11)
    s_waitcnt lgkmcnt(0)
    v_mfma_f32_16x16x32_bf16 v[24:27], v[104:107], v[240:243], v[24:27]
    s_add_u32 s56, s23, 6
    s_cmp_ge_u32 s56, 12
    v_mfma_f32_16x16x32_bf16 v[28:31], v[108:111], v[240:243], v[28:31]
    ds_read_b128 v[124:127], v12 offset:0
    s_cselect_b32 s48, 12, 0
    s_sub_u32 s56, s56, s48
    v_mfma_f32_16x16x32_bf16 v[32:35], v[112:115], v[240:243], v[32:35]
    s_lshl_b32 s56, s56, 12
    s_add_u32 s56, s56, s51
    v_mfma_f32_16x16x32_bf16 v[36:39], v[116:119], v[240:243], v[36:39]
    ds_read_b128 v[128:131], v12 offset:1024
    v_mfma_f32_16x16x32_bf16 v[40:43], v[120:123], v[240:243], v[40:43]
    buffer_load_dwordx4 v[240:243], v5, s[40:43], s56 offen offset:0 sc1
    s_waitcnt vmcnt(11)
    v_mfma_f32_16x16x32_bf16 v[44:47], v[104:107], v[244:247], v[44:47]
    v_mfma_f32_16x16x32_bf16 v[48:51], v[108:111], v[244:247], v[48:51]
    ds_read_b128 v[132:135], v12 offset:2048
    v_mfma_f32_16x16x32_bf16 v[52:55], v[112:115], v[244:247], v[52:55]
    v_mfma_f32_16x16x32_bf16 v[56:59], v[116:119], v[244:247], v[56:59]
    ds_read_b128 v[136:139], v12 offset:3072
    v_mfma_f32_16x16x32_bf16 v[60:63], v[120:123], v[244:247], v[60:63]
    buffer_load_dwordx4 v[244:247], v5, s[40:43], s56 offen offset:1024 sc1
    s_waitcnt vmcnt(11)
    v_mfma_f32_16x16x32_bf16 v[64:67], v[104:107], v[248:251], v[64:67]
    v_mfma_f32_16x16x32_bf16 v[68:71], v[108:111], v[248:251], v[68:71]
    ds_read_b128 v[140:143], v12 offset:4096
    v_mfma_f32_16x16x32_bf16 v[72:75], v[112:115], v[248:251], v[72:75]
    v_mfma_f32_16x16x32_bf16 v[76:79], v[116:119], v[248:251], v[76:79]
    v_mfma_f32_16x16x32_bf16 v[80:83], v[120:123], v[248:251], v[80:83]
    buffer_load_dwordx4 v[248:251], v5, s[40:43], s56 offen offset:2048 sc1
    s_waitcnt vmcnt(11)
    v_mfma_f32_16x16x32_bf16 v[84:87], v[104:107], v[252:255], v[84:87]
    v_mfma_f32_16x16x32_bf16 v[88:91], v[108:111], v[252:255], v[88:91]
    v_mfma_f32_16x16x32_bf16 v[92:95], v[112:115], v[252:255], v[92:95]
    v_mfma_f32_16x16x32_bf16 v[96:99], v[116:119], v[252:255], v[96:99]
    v_mfma_f32_16x16x32_bf16 v[100:103], v[120:123], v[252:255], v[100:103]
    buffer_load_dwordx4 v[252:255], v5, s[40:43], s56 offen offset:3072 sc1
    s_waitcnt vmcnt(11)
    s_waitcnt lgkmcnt(0)
    v_mfma_f32_16x16x32_bf16 v[24:27], v[124:127], v[224:227], v[24:27]
    s_add_u32 s56, s23, 7
    s_cmp_ge_u32 s56, 12
    v_mfma_f32_16x16x32_bf16 v[28:31], v[128:131], v[224:227], v[28:31]
    ds_read_b128 v[104:107], v9 offset:0
    s_cselect_b32 s48, 12, 0
    s_sub_u32 s56, s56, s48
    v_mfma_f32_16x16x32_bf16 v[32:35], v[132:135], v[224:227], v[32:35]
    s_lshl_b32 s56, s56, 12
    s_add_u32 s56, s56, s51
    v_mfma_f32_16x16x32_bf16 v[36:39], v[136:139], v[224:227], v[36:39]
    ds_read_b128 v[108:111], v9 offset:1024
    v_mfma_f32_16x16x32_bf16 v[40:43], v[140:143], v[224:227], v[40:43]
    buffer_load_dwordx4 v[224:227], v5, s[40:43], s56 offen offset:0 sc1
    s_waitcnt vmcnt(11)
    v_mfma_f32_16x16x32_bf16 v[44:47], v[124:127], v[228:231], v[44:47]
    v_mfma_f32_16x16x32_bf16 v[48:51], v[128:131], v[228:231], v[48:51]
    ds_read_b128 v[112:115], v9 offset:2048
    v_mfma_f32_16x16x32_bf16 v[52:55], v[132:135], v[228:231], v[52:55]
    v_mfma_f32_16x16x32_bf16 v[56:59], v[136:139], v[228:231], v[56:59]
    ds_read_b128 v[116:119], v9 offset:3072
    v_mfma_f32_16x16x32_bf16 v[60:63], v[140:143], v[228:231], v[60:63]
    buffer_load_dwordx4 v[228:231], v5, s[40:43], s56 offen offset:1024 sc1
    s_waitcnt vmcnt(11)
    v_mfma_f32_16x16x32_bf16 v[64:67], v[124:127], v[232:235], v[64:67]
    v_mfma_f32_16x16x32_bf16 v[68:71], v[128:131], v[232:235], v[68:71]
    ds_read_b128 v[120:123], v9 offset:4096
    v_mfma_f32_16x16x32_bf16 v[72:75], v[132:135], v[232:235], v[72:75]
    v_mfma_f32_16x16x32_bf16 v[76:79], v[136:139], v[232:235], v[76:79]
    v_mfma_f32_16x16x32_bf16 v[80:83], v[140:143], v[232:235], v[80:83]
    buffer_load_dwordx4 v[232:235], v5, s[40:43], s56 offen offset:2048 sc1
    s_waitcnt vmcnt(11)
    v_mfma_f32_16x16x32_bf16 v[84:87], v[124:127], v[236:239], v[84:87]
    v_mfma_f32_16x16x32_bf16 v[88:91], v[128:131], v[236:239], v[88:91]
    v_mfma_f32_16x16x32_bf16 v[92:95], v[132:135], v[236:239], v[92:95]
    v_mfma_f32_16x16x32_bf16 v[96:99], v[136:139], v[236:239], v[96:99]
    v_mfma_f32_16x16x32_bf16 v[100:103], v[140:143], v[236:239], v[100:103]
    buffer_load_dwordx4 v[236:239], v5, s[40:43], s56 offen offset:3072 sc1
    s_waitcnt vmcnt(11)
    s_waitcnt lgkmcnt(0)
    v_mfma_f32_16x16x32_bf16 v[24:27], v[104:107], v[144:147], v[24:27]
    s_add_u32 s56, s23, 8
    s_cmp_ge_u32 s56, 12
    v_mfma_f32_16x16x32_bf16 v[28:31], v[108:111], v[144:147], v[28:31]
    ds_read_b128 v[124:127], v9 offset:20480
    s_cselect_b32 s48, 12, 0
    s_sub_u32 s56, s56, s48
    v_mfma_f32_16x16x32_bf16 v[32:35], v[112:115], v[144:147], v[32:35]
    s_lshl_b32 s56, s56, 12
    s_add_u32 s56, s56, s51
    v_mfma_f32_16x16x32_bf16 v[36:39], v[116:119], v[144:147], v[36:39]
    ds_read_b128 v[128:131], v9 offset:21504
    v_mfma_f32_16x16x32_bf16 v[40:43], v[120:123], v[144:147], v[40:43]
    buffer_load_dwordx4 v[144:147], v5, s[40:43], s56 offen offset:0 sc1
    s_waitcnt vmcnt(11)
    v_mfma_f32_16x16x32_bf16 v[44:47], v[104:107], v[148:151], v[44:47]
    v_mfma_f32_16x16x32_bf16 v[48:51], v[108:111], v[148:151], v[48:51]
    ds_read_b128 v[132:135], v9 offset:22528
    v_mfma_f32_16x16x32_bf16 v[52:55], v[112:115], v[148:151], v[52:55]
    v_mfma_f32_16x16x32_bf16 v[56:59], v[116:119], v[148:151], v[56:59]
    ds_read_b128 v[136:139], v9 offset:23552
    v_mfma_f32_16x16x32_bf16 v[60:63], v[120:123], v[148:151], v[60:63]
    buffer_load_dwordx4 v[148:151], v5, s[40:43], s56 offen offset:1024 sc1
    s_waitcnt vmcnt(11)
    v_mfma_f32_16x16x32_bf16 v[64:67], v[104:107], v[152:155], v[64:67]
    v_mfma_f32_16x16x32_bf16 v[68:71], v[108:111], v[152:155], v[68:71]
    ds_read_b128 v[140:143], v9 offset:24576
    v_mfma_f32_16x16x32_bf16 v[72:75], v[112:115], v[152:155], v[72:75]
    v_mfma_f32_16x16x32_bf16 v[76:79], v[116:119], v[152:155], v[76:79]
    v_mfma_f32_16x16x32_bf16 v[80:83], v[120:123], v[152:155], v[80:83]
    buffer_load_dwordx4 v[152:155], v5, s[40:43], s56 offen offset:2048 sc1
    s_waitcnt vmcnt(11)
    v_mfma_f32_16x16x32_bf16 v[84:87], v[104:107], v[156:159], v[84:87]
    v_mfma_f32_16x16x32_bf16 v[88:91], v[108:111], v[156:159], v[88:91]
    v_mfma_f32_16x16x32_bf16 v[92:95], v[112:115], v[156:159], v[92:95]
    v_mfma_f32_16x16x32_bf16 v[96:99], v[116:119], v[156:159], v[96:99]
    v_mfma_f32_16x16x32_bf16 v[100:103], v[120:123], v[156:159], v[100:103]
    buffer_load_dwordx4 v[156:159], v5, s[40:43], s56 offen offset:3072 sc1
    s_waitcnt vmcnt(11)
    s_waitcnt lgkmcnt(0)
    v_mfma_f32_16x16x32_bf16 v[24:27], v[124:127], v[240:243], v[24:27]
    s_add_u32 s56, s23, 9
    s_cmp_ge_u32 s56, 12
    v_mfma_f32_16x16x32_bf16 v[28:31], v[128:131], v[240:243], v[28:31]
    ds_read_b128 v[104:107], v8 offset:20480
    s_cselect_b32 s48, 12, 0
    s_sub_u32 s56, s56, s48
    v_mfma_f32_16x16x32_bf16 v[32:35], v[132:135], v[240:243], v[32:35]
    s_lshl_b32 s56, s56, 12
    s_add_u32 s56, s56, s51
    v_mfma_f32_16x16x32_bf16 v[36:39], v[136:139], v[240:243], v[36:39]
    ds_read_b128 v[108:111], v8 offset:21504
    v_mfma_f32_16x16x32_bf16 v[40:43], v[140:143], v[240:243], v[40:43]
    buffer_load_dwordx4 v[240:243], v5, s[40:43], s56 offen offset:0 sc1
    s_waitcnt vmcnt(11)
    v_mfma_f32_16x16x32_bf16 v[44:47], v[124:127], v[244:247], v[44:47]
    v_mfma_f32_16x16x32_bf16 v[48:51], v[128:131], v[244:247], v[48:51]
    ds_read_b128 v[112:115], v8 offset:22528
    v_mfma_f32_16x16x32_bf16 v[52:55], v[132:135], v[244:247], v[52:55]
    v_mfma_f32_16x16x32_bf16 v[56:59], v[136:139], v[244:247], v[56:59]
    ds_read_b128 v[116:119], v8 offset:23552
    v_mfma_f32_16x16x32_bf16 v[60:63], v[140:143], v[244:247], v[60:63]
    buffer_load_dwordx4 v[244:247], v5, s[40:43], s56 offen offset:1024 sc1
    s_waitcnt vmcnt(11)
    v_mfma_f32_16x16x32_bf16 v[64:67], v[124:127], v[248:251], v[64:67]
    v_mfma_f32_16x16x32_bf16 v[68:71], v[128:131], v[248:251], v[68:71]
    ds_read_b128 v[120:123], v8 offset:24576
    v_mfma_f32_16x16x32_bf16 v[72:75], v[132:135], v[248:251], v[72:75]
    v_mfma_f32_16x16x32_bf16 v[76:79], v[136:139], v[248:251], v[76:79]
    v_mfma_f32_16x16x32_bf16 v[80:83], v[140:143], v[248:251], v[80:83]
    buffer_load_dwordx4 v[248:251], v5, s[40:43], s56 offen offset:2048 sc1
    s_waitcnt vmcnt(11)
    v_mfma_f32_16x16x32_bf16 v[84:87], v[124:127], v[252:255], v[84:87]
    v_mfma_f32_16x16x32_bf16 v[88:91], v[128:131], v[252:255], v[88:91]
    v_mfma_f32_16x16x32_bf16 v[92:95], v[132:135], v[252:255], v[92:95]
    v_mfma_f32_16x16x32_bf16 v[96:99], v[136:139], v[252:255], v[96:99]
    v_mfma_f32_16x16x32_bf16 v[100:103], v[140:143], v[252:255], v[100:103]
    buffer_load_dwordx4 v[252:255], v5, s[40:43], s56 offen offset:3072 sc1
    s_waitcnt vmcnt(11)
    s_waitcnt lgkmcnt(0)
    v_mfma_f32_16x16x32_bf16 v[24:27], v[104:107], v[224:227], v[24:27]
    s_add_u32 s56, s23, 10
    s_cmp_ge_u32 s56, 12
    v_mfma_f32_16x16x32_bf16 v[28:31], v[108:111], v[224:227], v[28:31]
    ds_read_b128 v[124:127], v9 offset:40960
    s_cselect_b32 s48, 12, 0
    s_sub_u32 s56, s56, s48
    v_mfma_f32_16x16x32_bf16 v[32:35], v[112:115], v[224:227], v[32:35]
    s_lshl_b32 s56, s56, 12
    s_add_u32 s56, s56, s51
    v_mfma_f32_16x16x32_bf16 v[36:39], v[116:119], v[224:227], v[36:39]
    ds_read_b128 v[128:131], v9 offset:41984
    v_mfma_f32_16x16x32_bf16 v[40:43], v[120:123], v[224:227], v[40:43]
    buffer_load_dwordx4 v[224:227], v5, s[40:43], s56 offen offset:0 sc1
    s_waitcnt vmcnt(11)
    v_mfma_f32_16x16x32_bf16 v[44:47], v[104:107], v[228:231], v[44:47]
    v_mfma_f32_16x16x32_bf16 v[48:51], v[108:111], v[228:231], v[48:51]
    ds_read_b128 v[132:135], v9 offset:43008
    v_mfma_f32_16x16x32_bf16 v[52:55], v[112:115], v[228:231], v[52:55]
    v_mfma_f32_16x16x32_bf16 v[56:59], v[116:119], v[228:231], v[56:59]
    ds_read_b128 v[136:139], v9 offset:44032
    v_mfma_f32_16x16x32_bf16 v[60:63], v[120:123], v[228:231], v[60:63]
    buffer_load_dwordx4 v[228:231], v5, s[40:43], s56 offen offset:1024 sc1
    s_waitcnt vmcnt(11)
    v_mfma_f32_16x16x32_bf16 v[64:67], v[104:107], v[232:235], v[64:67]
    v_mfma_f32_16x16x32_bf16 v[68:71], v[108:111], v[232:235], v[68:71]
    ds_read_b128 v[140:143], v9 offset:45056
    v_mfma_f32_16x16x32_bf16 v[72:75], v[112:115], v[232:235], v[72:75]
    v_mfma_f32_16x16x32_bf16 v[76:79], v[116:119], v[232:235], v[76:79]
    v_mfma_f32_16x16x32_bf16 v[80:83], v[120:123], v[232:235], v[80:83]
    buffer_load_dwordx4 v[232:235], v5, s[40:43], s56 offen offset:2048 sc1
    s_waitcnt vmcnt(11)
    v_mfma_f32_16x16x32_bf16 v[84:87], v[104:107], v[236:239], v[84:87]
    v_mfma_f32_16x16x32_bf16 v[88:91], v[108:111], v[236:239], v[88:91]
    v_mfma_f32_16x16x32_bf16 v[92:95], v[112:115], v[236:239], v[92:95]
    v_mfma_f32_16x16x32_bf16 v[96:99], v[116:119], v[236:239], v[96:99]
    v_mfma_f32_16x16x32_bf16 v[100:103], v[120:123], v[236:239], v[100:103]
    buffer_load_dwordx4 v[236:239], v5, s[40:43], s56 offen offset:3072 sc1
    s_waitcnt vmcnt(11)
    s_waitcnt lgkmcnt(0)
    s_mov_b64 exec, 1
    ds_write_b32 v13, v14 offset:96
    s_mov_b64 exec, -1
    v_mfma_f32_16x16x32_bf16 v[24:27], v[124:127], v[144:147], v[24:27]
    s_add_u32 s56, s23, 11
    s_cmp_ge_u32 s56, 12
    v_mfma_f32_16x16x32_bf16 v[28:31], v[128:131], v[144:147], v[28:31]
    s_cselect_b32 s48, 12, 0
    s_sub_u32 s56, s56, s48
    v_mfma_f32_16x16x32_bf16 v[32:35], v[132:135], v[144:147], v[32:35]
    s_lshl_b32 s56, s56, 12
    s_add_u32 s56, s56, s51
    v_mfma_f32_16x16x32_bf16 v[36:39], v[136:139], v[144:147], v[36:39]
    v_mfma_f32_16x16x32_bf16 v[40:43], v[140:143], v[144:147], v[40:43]
    buffer_load_dwordx4 v[144:147], v5, s[40:43], s56 offen offset:0 sc1
    s_waitcnt vmcnt(11)
    v_mfma_f32_16x16x32_bf16 v[44:47], v[124:127], v[148:151], v[44:47]
    v_mfma_f32_16x16x32_bf16 v[48:51], v[128:131], v[148:151], v[48:51]
    v_mfma_f32_16x16x32_bf16 v[52:55], v[132:135], v[148:151], v[52:55]
    v_mfma_f32_16x16x32_bf16 v[56:59], v[136:139], v[148:151], v[56:59]
    v_mfma_f32_16x16x32_bf16 v[60:63], v[140:143], v[148:151], v[60:63]
    buffer_load_dwordx4 v[148:151], v5, s[40:43], s56 offen offset:1024 sc1
    s_waitcnt vmcnt(11)
    v_mfma_f32_16x16x32_bf16 v[64:67], v[124:127], v[152:155], v[64:67]
    v_mfma_f32_16x16x32_bf16 v[68:71], v[128:131], v[152:155], v[68:71]
    v_mfma_f32_16x16x32_bf16 v[72:75], v[132:135], v[152:155], v[72:75]
    v_mfma_f32_16x16x32_bf16 v[76:79], v[136:139], v[152:155], v[76:79]
    v_mfma_f32_16x16x32_bf16 v[80:83], v[140:143], v[152:155], v[80:83]
    buffer_load_dwordx4 v[152:155], v5, s[40:43], s56 offen offset:2048 sc1
    s_waitcnt vmcnt(11)
    v_mfma_f32_16x16x32_bf16 v[84:87], v[124:127], v[156:159], v[84:87]
    v_mfma_f32_16x16x32_bf16 v[88:91], v[128:131], v[156:159], v[88:91]
    v_mfma_f32_16x16x32_bf16 v[92:95], v[132:135], v[156:159], v[92:95]
    v_mfma_f32_16x16x32_bf16 v[96:99], v[136:139], v[156:159], v[96:99]
    v_mfma_f32_16x16x32_bf16 v[100:103], v[140:143], v[156:159], v[100:103]
    buffer_load_dwordx4 v[156:159], v5, s[40:43], s56 offen offset:3072 sc1
    s_waitcnt vmcnt(11)
    v_mfma_f32_16x16x32_bf16 v[24:27], v[164:167], v[240:243], v[24:27]
    v_mfma_f32_16x16x32_bf16 v[28:31], v[168:171], v[240:243], v[28:31]
    v_mfma_f32_16x16x32_bf16 v[32:35], v[172:175], v[240:243], v[32:35]
    v_mfma_f32_16x16x32_bf16 v[36:39], v[176:179], v[240:243], v[36:39]
    v_mfma_f32_16x16x32_bf16 v[40:43], v[180:183], v[240:243], v[40:43]
    s_waitcnt vmcnt(10)
    v_mfma_f32_16x16x32_bf16 v[44:47], v[164:167], v[244:247], v[44:47]
    v_mfma_f32_16x16x32_bf16 v[48:51], v[168:171], v[244:247], v[48:51]
    v_mfma_f32_16x16x32_bf16 v[52:55], v[172:175], v[244:247], v[52:55]
    v_mfma_f32_16x16x32_bf16 v[56:59], v[176:179], v[244:247], v[56:59]
    v_mfma_f32_16x16x32_bf16 v[60:63], v[180:183], v[244:247], v[60:63]
    s_waitcnt vmcnt(9)
    v_mfma_f32_16x16x32_bf16 v[64:67], v[164:167], v[248:251], v[64:67]
    v_mfma_f32_16x16x32_bf16 v[68:71], v[168:171], v[248:251], v[68:71]
    v_mfma_f32_16x16x32_bf16 v[72:75], v[172:175], v[248:251], v[72:75]
    v_mfma_f32_16x16x32_bf16 v[76:79], v[176:179], v[248:251], v[76:79]
    v_mfma_f32_16x16x32_bf16 v[80:83], v[180:183], v[248:251], v[80:83]
    s_waitcnt vmcnt(8)
    v_mfma_f32_16x16x32_bf16 v[84:87], v[164:167], v[252:255], v[84:87]
    v_mfma_f32_16x16x32_bf16 v[88:91], v[168:171], v[252:255], v[88:91]
    v_mfma_f32_16x16x32_bf16 v[92:95], v[172:175], v[252:255], v[92:95]
    v_mfma_f32_16x16x32_bf16 v[96:99], v[176:179], v[252:255], v[96:99]
    v_mfma_f32_16x16x32_bf16 v[100:103], v[180:183], v[252:255], v[100:103]
    s_waitcnt vmcnt(7)
    v_mfma_f32_16x16x32_bf16 v[24:27], v[184:187], v[224:227], v[24:27]
    v_mfma_f32_16x16x32_bf16 v[28:31], v[188:191], v[224:227], v[28:31]
    v_mfma_f32_16x16x32_bf16 v[32:35], v[192:195], v[224:227], v[32:35]
    v_mfma_f32_16x16x32_bf16 v[36:39], v[196:199], v[224:227], v[36:39]
    v_mfma_f32_16x16x32_bf16 v[40:43], v[200:203], v[224:227], v[40:43]
    s_waitcnt vmcnt(6)
    v_mfma_f32_16x16x32_bf16 v[44:47], v[184:187], v[228:231], v[44:47]
    v_mfma_f32_16x16x32_bf16 v[48:51], v[188:191], v[228:231], v[48:51]
    v_mfma_f32_16x16x32_bf16 v[52:55], v[192:195], v[228:231], v[52:55]
    v_mfma_f32_16x16x32_bf16 v[56:59], v[196:199], v[228:231], v[56:59]
    v_mfma_f32_16x16x32_bf16 v[60:63], v[200:203], v[228:231], v[60:63]
    s_waitcnt vmcnt(5)
    v_mfma_f32_16x16x32_bf16 v[64:67], v[184:187], v[232:235], v[64:67]
    v_mfma_f32_16x16x32_bf16 v[68:71], v[188:191], v[232:235], v[68:71]
    v_mfma_f32_16x16x32_bf16 v[72:75], v[192:195], v[232:235], v[72:75]
    v_mfma_f32_16x16x32_bf16 v[76:79], v[196:199], v[232:235], v[76:79]
    v_mfma_f32_16x16x32_bf16 v[80:83], v[200:203], v[232:235], v[80:83]
    s_waitcnt vmcnt(4)
    v_mfma_f32_16x16x32_bf16 v[84:87], v[184:187], v[236:239], v[84:87]
    v_mfma_f32_16x16x32_bf16 v[88:91], v[188:191], v[236:239], v[88:91]
    v_mfma_f32_16x16x32_bf16 v[92:95], v[192:195], v[236:239], v[92:95]
    v_mfma_f32_16x16x32_bf16 v[96:99], v[196:199], v[236:239], v[96:99]
    v_mfma_f32_16x16x32_bf16 v[100:103], v[200:203], v[236:239], v[100:103]
    s_waitcnt vmcnt(3)
    v_mfma_f32_16x16x32_bf16 v[24:27], v[204:207], v[144:147], v[24:27]
    v_mfma_f32_16x16x32_bf16 v[28:31], v[208:211], v[144:147], v[28:31]
    v_mfma_f32_16x16x32_bf16 v[32:35], v[212:215], v[144:147], v[32:35]
    v_mfma_f32_16x16x32_bf16 v[36:39], v[216:219], v[144:147], v[36:39]
    v_mfma_f32_16x16x32_bf16 v[40:43], v[220:223], v[144:147], v[40:43]
    s_waitcnt vmcnt(2)
    v_mfma_f32_16x16x32_bf16 v[44:47], v[204:207], v[148:151], v[44:47]
    v_mfma_f32_16x16x32_bf16 v[48:51], v[208:211], v[148:151], v[48:51]
    v_mfma_f32_16x16x32_bf16 v[52:55], v[212:215], v[148:151], v[52:55]
    v_mfma_f32_16x16x32_bf16 v[56:59], v[216:219], v[148:151], v[56:59]
    v_mfma_f32_16x16x32_bf16 v[60:63], v[220:223], v[148:151], v[60:63]
    s_waitcnt vmcnt(1)
    v_mfma_f32_16x16x32_bf16 v[64:67], v[204:207], v[152:155], v[64:67]
    ds_write_b128 v8, v[24:27] offset:49152
    v_mfma_f32_16x16x32_bf16 v[68:71], v[208:211], v[152:155], v[68:71]
    ds_write_b128 v8, v[28:31] offset:50176
    v_mfma_f32_16x16x32_bf16 v[72:75], v[212:215], v[152:155], v[72:75]
    ds_write_b128 v8, v[32:35] offset:51200
    v_mfma_f32_16x16x32_bf16 v[76:79], v[216:219], v[152:155], v[76:79]
    ds_write_b128 v8, v[36:39] offset:52224
    v_mfma_f32_16x16x32_bf16 v[80:83], v[220:223], v[152:155], v[80:83]
    ds_write_b128 v8, v[40:43] offset:53248
    s_waitcnt vmcnt(0)
    v_mfma_f32_16x16x32_bf16 v[84:87], v[204:207], v[156:159], v[84:87]
    ds_write_b128 v12, v[44:47] offset:0
    v_mfma_f32_16x16x32_bf16 v[88:91], v[208:211], v[156:159], v[88:91]
    ds_write_b128 v12, v[48:51] offset:1024
    v_mfma_f32_16x16x32_bf16 v[92:95], v[212:215], v[156:159], v[92:95]
    ds_write_b128 v12, v[52:55] offset:2048
    v_mfma_f32_16x16x32_bf16 v[96:99], v[216:219], v[156:159], v[96:99]
    ds_write_b128 v12, v[56:59] offset:3072
    v_mfma_f32_16x16x32_bf16 v[100:103], v[220:223], v[156:159], v[100:103]
    ds_write_b128 v12, v[60:63] offset:4096
    ds_write_b128 v9, v[64:67] offset:0
    ds_write_b128 v9, v[68:71] offset:1024
    ds_write_b128 v9, v[72:75] offset:2048
    ds_write_b128 v9, v[76:79] offset:3072
    ds_write_b128 v9, v[80:83] offset:4096
    ds_write_b128 v9, v[84:87] offset:20480
    ds_write_b128 v9, v[88:91] offset:21504
    ds_write_b128 v9, v[92:95] offset:22528
    ds_write_b128 v9, v[96:99] offset:23552
    ds_write_b128 v9, v[100:103] offset:24576
    s_waitcnt lgkmcnt(0)
    s_barrier
    ds_read_b128 v[104:107], v15 offset:3072
    ds_read_b128 v[108:111], v15 offset:4096
    ds_read_b128 v[112:115], v15 offset:8192
    ds_read_b128 v[116:119], v15 offset:9216
    ds_read_b128 v[120:123], v15 offset:13312
    ds_read_b128 v[124:127], v15 offset:14336
    ds_read_b128 v[128:131], v15 offset:18432
    ds_read_b128 v[132:135], v15 offset:19456
    ds_read_b32 v18, v19 offset:46080
    s_waitcnt lgkmcnt(5)
    ds_read_b128 v[136:139], v16 offset:3072
    ds_read_b128 v[140:143], v16 offset:4096
    ds_read_b128 v[144:147], v16 offset:8192
    ds_read_b128 v[148:151], v16 offset:9216
    ds_read_b128 v[152:155], v16 offset:13312
    ds_read_b128 v[156:159], v16 offset:14336
    ds_read_b128 v[160:163], v17 offset:0
    ds_read_b128 v[164:167], v17 offset:1024
    v_pk_add_f32 v[104:105], v[104:105], v[112:113]
    v_pk_add_f32 v[106:107], v[106:107], v[114:115]
    v_pk_add_f32 v[108:109], v[108:109], v[116:117]
    v_pk_add_f32 v[110:111], v[110:111], v[118:119]
    s_waitcnt lgkmcnt(8)
    v_mov_b32 v19, v18
    v_pk_add_f32 v[120:121], v[120:121], v[128:129]
    v_pk_add_f32 v[122:123], v[122:123], v[130:131]
    v_pk_add_f32 v[124:125], v[124:125], v[132:133]
    v_pk_add_f32 v[126:127], v[126:127], v[134:135]
    v_pk_add_f32 v[104:105], v[104:105], v[120:121]
    v_pk_add_f32 v[106:107], v[106:107], v[122:123]
    v_pk_add_f32 v[108:109], v[108:109], v[124:125]
    v_pk_add_f32 v[110:111], v[110:111], v[126:127]
    s_waitcnt lgkmcnt(0)
    v_pk_fma_f32 v[104:105], v[104:105], v[18:19], v[160:161]
    v_pk_fma_f32 v[106:107], v[106:107], v[18:19], v[162:163]
    v_pk_fma_f32 v[108:109], v[108:109], v[18:19], v[164:165]
    v_pk_fma_f32 v[110:111], v[110:111], v[18:19], v[166:167]
    v_pk_add_f32 v[104:105], v[104:105], v[136:137]
    v_pk_add_f32 v[106:107], v[106:107], v[138:139]
    v_pk_add_f32 v[108:109], v[108:109], v[140:141]
    v_pk_add_f32 v[110:111], v[110:111], v[142:143]
    v_pk_add_f32 v[104:105], v[104:105], v[144:145]
    v_pk_add_f32 v[106:107], v[106:107], v[146:147]
    v_pk_add_f32 v[108:109], v[108:109], v[148:149]
    v_pk_add_f32 v[110:111], v[110:111], v[150:151]
    v_pk_add_f32 v[104:105], v[104:105], v[152:153]
    v_pk_add_f32 v[106:107], v[106:107], v[154:155]
    v_pk_add_f32 v[108:109], v[108:109], v[156:157]
    v_pk_add_f32 v[110:111], v[110:111], v[158:159]
    v_cvt_pk_bf16_f32 v104, v104, v105
    v_cvt_pk_bf16_f32 v105, v106, v107
    buffer_store_dwordx2 v[104:105], v20, s[28:31], s55 offen offset:96
    v_cvt_pk_bf16_f32 v108, v108, v109
    v_cvt_pk_bf16_f32 v109, v110, v111
    buffer_store_dwordx2 v[108:109], v20, s[28:31], s55 offen offset:128
    s_endpgm
L_compute:
    s_cmp_lg_u32 s21, 0
    s_cbranch_scc1 L_nocpf
    s_getpc_b64 s[44:45]
L_pc:
    s_sub_u32 s44, s44, L_pc-gated_mix__linear_attn_block__glu_gated_glu__prompt_kernel
    s_subb_u32 s45, s45, 0
    s_mov_b32 s46, L_end-gated_mix__linear_attn_block__glu_gated_glu__prompt_kernel
    s_mov_b32 s47, 0x20000
    s_lshr_b32 s48, s2, 3
    s_lshl_b32 s48, s48, 11
    v_lshlrev_b32 v3, 7, v2
    s_mov_b64 exec, 0xffff
    buffer_load_dword v95, v3, s[44:47], s48 offen
    s_mov_b64 exec, -1
L_nocpf:
    s_barrier
    v_mov_b64 v[96:97], 0
    v_mov_b64 v[98:99], 0
    v_mov_b64 v[100:101], 0
    v_mov_b64 v[102:103], 0
    v_mov_b64 v[104:105], 0
    v_mov_b64 v[106:107], 0
    v_mov_b64 v[108:109], 0
    v_mov_b64 v[110:111], 0
    v_mov_b64 v[112:113], 0
    v_mov_b64 v[114:115], 0
    v_mov_b64 v[116:117], 0
    v_mov_b64 v[118:119], 0
    v_mov_b64 v[120:121], 0
    v_mov_b64 v[122:123], 0
    v_mov_b64 v[124:125], 0
    v_mov_b64 v[126:127], 0
    v_mov_b64 v[128:129], 0
    v_mov_b64 v[130:131], 0
    v_mov_b64 v[132:133], 0
    v_mov_b64 v[134:135], 0
    v_mov_b64 v[136:137], 0
    v_mov_b64 v[138:139], 0
    v_mov_b64 v[140:141], 0
    v_mov_b64 v[142:143], 0
    v_mov_b64 v[144:145], 0
    v_mov_b64 v[146:147], 0
    v_mov_b64 v[148:149], 0
    v_mov_b64 v[150:151], 0
    v_mov_b64 v[152:153], 0
    v_mov_b64 v[154:155], 0
    v_mov_b64 v[156:157], 0
    v_mov_b64 v[158:159], 0
    v_mov_b64 v[160:161], 0
    v_mov_b64 v[162:163], 0
    v_mov_b64 v[164:165], 0
    v_mov_b64 v[166:167], 0
    v_mov_b64 v[168:169], 0
    v_mov_b64 v[170:171], 0
    v_mov_b64 v[172:173], 0
    v_mov_b64 v[174:175], 0
    v_mov_b64 v[176:177], 0
    v_mov_b64 v[178:179], 0
    v_mov_b64 v[180:181], 0
    v_mov_b64 v[182:183], 0
    v_mov_b64 v[184:185], 0
    v_mov_b64 v[186:187], 0
    v_mov_b64 v[188:189], 0
    v_mov_b64 v[190:191], 0
    v_mov_b64 v[192:193], 0
    v_mov_b64 v[194:195], 0
    v_mov_b64 v[196:197], 0
    v_mov_b64 v[198:199], 0
    v_mov_b64 v[200:201], 0
    v_mov_b64 v[202:203], 0
    v_mov_b64 v[204:205], 0
    v_mov_b64 v[206:207], 0
    v_mov_b64 v[208:209], 0
    v_mov_b64 v[210:211], 0
    v_mov_b64 v[212:213], 0
    v_mov_b64 v[214:215], 0
    v_mov_b64 v[216:217], 0
    v_mov_b64 v[218:219], 0
    v_mov_b64 v[220:221], 0
    v_mov_b64 v[222:223], 0
    v_mov_b64 v[224:225], 0
    v_mov_b64 v[226:227], 0
    v_mov_b64 v[228:229], 0
    v_mov_b64 v[230:231], 0
    v_mov_b64 v[232:233], 0
    v_mov_b64 v[234:235], 0
    v_mov_b64 v[236:237], 0
    v_mov_b64 v[238:239], 0
    v_mov_b64 v[240:241], 0
    v_mov_b64 v[242:243], 0
    v_mov_b64 v[244:245], 0
    v_mov_b64 v[246:247], 0
    v_mov_b64 v[248:249], 0
    v_mov_b64 v[250:251], 0
    v_mov_b64 v[252:253], 0
    v_mov_b64 v[254:255], 0
    v_lshrrev_b32 v3, 4, v2
    v_bfe_u32 v4, v2, 2, 2
    v_and_b32 v5, 3, v2
    v_lshrrev_b32 v6, 1, v4
    v_and_b32 v8, 1, v3
    v_lshl_add_u32 v6, v8, 1, v6
    v_lshlrev_b32 v6, 5, v6
    v_mul_u32_u24 v7, 5120, v3
    v_lshl_add_u32 v7, v4, 7, v7
    v_and_b32 v8, 15, v2
    v_lshrrev_b32 v9, 1, v8
    v_xor_b32 v9, v9, v3
    v_lshlrev_b32 v9, 4, v9
    v_lshl_add_u32 v20, v8, 7, v9
    v_xor_b32 v21, 64, v20
    s_mov_b32 s60, 1069066811
    s_mov_b32 s61, 1069066811
    s_mov_b32 s62, 3216550459
    s_mov_b32 s63, 3216550459
    s_mov_b32 s64, 1.0
    s_mov_b32 s65, 1.0
    s_mov_b32 s66, 897988541
    s_waitcnt lgkmcnt(0)
    s_mov_b32 s40, s16
    s_mov_b32 s41, s17
    s_mov_b32 s42, 17825792
    s_mov_b32 s43, 0x20000
    s_cmp_eq_u32 s20, 0
    s_cbranch_scc1 L_kv
    s_cmp_lg_u32 s20, 3
    s_cbranch_scc1 L_g_nowo
    s_load_dwordx2 s[24:25], s[0:1], 16
    s_mov_b32 s26, 819200
    s_mov_b32 s27, 0x20000
    s_and_b32 s69, s2, 7
    s_lshl_b32 s69, s69, 3
    s_bfe_u32 s48, s2, 0x30003
    s_add_u32 s69, s69, s48
    s_lshr_b32 s48, s69, 2
    s_lshl_b32 s48, s48, 1
    s_and_b32 s49, s21, 1
    s_add_u32 s48, s48, s49
    s_mul_i32 s48, s48, 25600
    s_and_b32 s49, s69, 3
    s_lshl_b32 s49, s49, 1
    s_lshr_b32 s56, s21, 1
    s_add_u32 s49, s49, s56
    s_mul_i32 s49, s49, 160
    s_add_u32 s73, s48, s49
    v_lshrrev_b32 v8, 1, v2
    v_mul_u32_u24 v8, 1280, v8
    v_and_b32 v9, 1, v2
    v_mul_u32_u24 v9, 156, v9
    v_add_u32 v8, v8, v9
    s_waitcnt lgkmcnt(0)
    buffer_load_dword v92, v8, s[24:27], s73 offen
L_g_nowo:
    s_lshr_b32 s48, s21, 1
    s_lshl_b32 s48, s48, 10
    s_and_b32 s49, s21, 1
    s_lshl_b32 s49, s49, 3
    v_add_u32 v8, s49, v5
    v_lshlrev_b32 v8, 3, v8
    v_xor_b32 v9, v8, v6
    v_add3_u32 v10, v9, v7, s48
    v_add_u32 v8, 32, v8
    v_xor_b32 v9, v8, v6
    v_add3_u32 v11, v9, v7, s48
    v_add_u32 v12, 2048, v10
    v_add_u32 v13, 2048, v11
    s_lshl_b32 s49, s21, 2
    v_add_u32 v8, s49, v5
    v_lshlrev_b32 v8, 3, v8
    v_xor_b32 v9, v8, v6
    v_add_u32 v14, v9, v7
    v_add_u32 v14, 4096, v14
    s_cmp_eq_u32 s55, 0
    s_cbranch_scc1 L_g_notgc
    v_lshlrev_b32 v14, 5, v3
    v_lshl_add_u32 v14, v4, 3, v14
L_g_notgc:
    v_lshlrev_b32 v22, 4, v2
    s_mul_i32 s72, s18, 557056
    s_add_u32 s73, s72, 278528
    s_lshl_b32 s48, s22, 2
    s_add_u32 s48, s48, s21
    s_lshl_b32 s49, s48, 12
    s_add_u32 s70, s72, s49
    s_add_u32 s71, s73, s49
    s_lshl_b32 s74, s18, 13
    s_lshl_b32 s49, s48, 3
    s_add_u32 s74, s74, s49
    s_add_u32 s74, s74, 15990784
    s_lshl_b32 s48, s48, 2
    v_add_u32 v5, s48, v3
    v_mul_u32_u24 v6, 6554, v5
    v_lshrrev_b32 v6, 16, v6
    v_mul_u32_u24 v7, 10, v6
    v_sub_u32 v7, v5, v7
    v_lshrrev_b32 v8, 2, v6
    v_and_b32 v6, 3, v6
    v_mul_u32_u24 v8, 5, v8
    v_lshrrev_b32 v9, 1, v7
    v_add3_u32 v8, v8, v9, 48
    v_lshlrev_b32 v8, 12, v8
    v_and_b32 v9, 15, v2
    v_lshl_add_u32 v9, v6, 4, v9
    v_lshl_add_u32 v8, v9, 4, v8
    v_and_b32 v7, 1, v7
    v_lshl_add_u32 v23, v7, 10, v8
    s_mov_b32 s50, 49152
    s_mov_b32 s51, 0
    s_mov_b32 s54, 0
    s_cmp_lg_u32 s55, 0
    s_cselect_b32 s52, 151552, s50
    s_movk_i32 s53, 20480
    s_cselect_b32 s53, 320, s53
    s_mov_b32 s57, 151552
    s_cselect_b32 s57, -1, s57
    v_add_u32 v15, s50, v10
    v_add_u32 v16, s50, v11
    v_add_u32 v17, s50, v12
    v_add_u32 v18, s50, v13
    v_add_u32 v19, s52, v14
    v_add_u32 v4, s51, v20
    v_add_u32 v5, s51, v21
    v_mov_b32 v3, 159744
    s_lshl_b32 s48, s21, 8
    s_add_u32 m0, s48, 160000
    v_mov_b32 v0, 2147418112
    v_writelane_b32 v0, 0, 0
    s_getpc_b64 s[44:45]
L_pc_51:
    s_add_u32 s44, s44, L_table-L_pc_51
    s_addc_u32 s45, s45, 0
    s_movk_i32 s46, 128
    s_mov_b32 s47, 0x20000
    s_mov_b32 s96, 0
L_lw_52:
    ds_read_b128 v[6:9], v3 offset:0
    s_waitcnt lgkmcnt(0)
    v_min3_u32 v6, v6, v7, v8
    v_min_u32 v6, v6, v9
    s_nop 0
    v_readfirstlane_b32 s59, v6
    s_cmp_ge_i32 s59, 1
    s_cbranch_scc1 L_lwd_53
    s_sleep 1
    s_add_u32 s96, s96, 1
    s_cmp_lt_u32 s96, 2097152
    s_cbranch_scc1 L_lw_52
L_lwd_53:
    s_waitcnt vmcnt(0)
    s_setprio 2
    ds_read_b64_tr_b16 v[24:25], v15 offset:0
    ds_read_b64_tr_b16 v[26:27], v15 offset:512
    ds_read_b64_tr_b16 v[28:29], v16 offset:0
    ds_read_b64_tr_b16 v[30:31], v16 offset:512
    ds_read_b64_tr_b16 v[32:33], v17 offset:0
    ds_read_b64_tr_b16 v[34:35], v17 offset:512
    ds_read_b64_tr_b16 v[36:37], v18 offset:0
    ds_read_b64_tr_b16 v[38:39], v18 offset:512
    ds_read_b64_tr_b16 v[40:41], v19 offset:0
    ds_read_b64_tr_b16 v[42:43], v19 offset:512
    s_waitcnt lgkmcnt(6)
    ds_read_b128 v[64:67], v4 offset:0
    ds_read_b128 v[68:71], v4 offset:2048
    ds_read_b128 v[72:75], v4 offset:4096
    ds_read_b128 v[76:79], v4 offset:6144
    ds_read_b128 v[80:83], v4 offset:8192
    ds_read_b128 v[84:87], v4 offset:10240
    ds_read_b128 v[88:91], v4 offset:12288
    ds_read_b128 v[92:95], v4 offset:14336
    s_add_u32 s50, s50, 20480
    s_cmp_ge_u32 s50, 151552
    s_cselect_b32 s50, 49152, s50
    s_add_u32 s52, s52, s53
    s_cmp_ge_u32 s52, s57
    s_cselect_b32 s52, 49152, s52
    v_add_u32 v15, s50, v10
    v_add_u32 v16, s50, v11
    v_add_u32 v17, s50, v12
    v_add_u32 v18, s50, v13
    v_add_u32 v19, s52, v14
    s_mov_b32 s58, 2
    s_cmp_ge_i32 s59, s58
    s_cbranch_scc0 L_g_slow0
    .p2align 3
L_g_go0:
    s_waitcnt lgkmcnt(2)
    v_mfma_f32_16x16x32_bf16 v[96:99], v[24:27], v[64:67], v[96:99]
    ds_read_b64_tr_b16 v[44:45], v15 offset:0
    v_mfma_f32_16x16x32_bf16 v[100:103], v[28:31], v[64:67], v[100:103]
    s_add_u32 s54, s54, 4
    v_mfma_f32_16x16x32_bf16 v[104:107], v[32:35], v[64:67], v[104:107]
    ds_read_b64_tr_b16 v[46:47], v15 offset:512
    v_mfma_f32_16x16x32_bf16 v[108:111], v[36:39], v[64:67], v[108:111]
    v_mfma_f32_16x16x32_bf16 v[112:115], v[40:43], v[64:67], v[112:115]
    ds_read_b128 v[64:67], v5 offset:0
    v_mfma_f32_16x16x32_bf16 v[116:119], v[24:27], v[68:71], v[116:119]
    ds_read_b64_tr_b16 v[48:49], v16 offset:0
    v_mfma_f32_16x16x32_bf16 v[120:123], v[28:31], v[68:71], v[120:123]
    s_add_u32 s58, s58, 1
    v_mfma_f32_16x16x32_bf16 v[124:127], v[32:35], v[68:71], v[124:127]
    ds_read_b64_tr_b16 v[50:51], v16 offset:512
    v_mfma_f32_16x16x32_bf16 v[128:131], v[36:39], v[68:71], v[128:131]
    s_min_u32 s58, s58, 20
    v_mfma_f32_16x16x32_bf16 v[132:135], v[40:43], v[68:71], v[132:135]
    ds_read_b128 v[68:71], v5 offset:2048
    s_waitcnt lgkmcnt(6)
    v_mfma_f32_16x16x32_bf16 v[136:139], v[24:27], v[72:75], v[136:139]
    ds_read_b64_tr_b16 v[52:53], v17 offset:0
    v_mfma_f32_16x16x32_bf16 v[140:143], v[28:31], v[72:75], v[140:143]
    buffer_load_dword v0, s[44:47], s54 offen lds
    v_mfma_f32_16x16x32_bf16 v[144:147], v[32:35], v[72:75], v[144:147]
    ds_read_b64_tr_b16 v[54:55], v17 offset:512
    v_mfma_f32_16x16x32_bf16 v[148:151], v[36:39], v[72:75], v[148:151]
    s_add_u32 s50, s50, 20480
    s_cmp_ge_u32 s50, 151552
    v_mfma_f32_16x16x32_bf16 v[152:155], v[40:43], v[72:75], v[152:155]
    ds_read_b128 v[72:75], v5 offset:4096
    v_mfma_f32_16x16x32_bf16 v[156:159], v[24:27], v[76:79], v[156:159]
    ds_read_b64_tr_b16 v[56:57], v18 offset:0
    v_mfma_f32_16x16x32_bf16 v[160:163], v[28:31], v[76:79], v[160:163]
    s_cselect_b32 s50, 49152, s50
    s_add_u32 s52, s52, s53
    v_mfma_f32_16x16x32_bf16 v[164:167], v[32:35], v[76:79], v[164:167]
    ds_read_b64_tr_b16 v[58:59], v18 offset:512
    v_mfma_f32_16x16x32_bf16 v[168:171], v[36:39], v[76:79], v[168:171]
    s_cmp_ge_u32 s52, s57
    s_cselect_b32 s52, 49152, s52
    v_mfma_f32_16x16x32_bf16 v[172:175], v[40:43], v[76:79], v[172:175]
    ds_read_b128 v[76:79], v5 offset:6144
    v_mfma_f32_16x16x32_bf16 v[176:179], v[24:27], v[80:83], v[176:179]
    ds_read_b64_tr_b16 v[60:61], v19 offset:0
    v_mfma_f32_16x16x32_bf16 v[180:183], v[28:31], v[80:83], v[180:183]
    s_add_u32 s51, s51, 16384
    s_cmp_ge_u32 s51, 49152
    v_mfma_f32_16x16x32_bf16 v[184:187], v[32:35], v[80:83], v[184:187]
    ds_read_b64_tr_b16 v[62:63], v19 offset:512
    v_mfma_f32_16x16x32_bf16 v[188:191], v[36:39], v[80:83], v[188:191]
    s_cselect_b32 s51, 0, s51
    v_add_u32 v15, s50, v10
    v_mfma_f32_16x16x32_bf16 v[192:195], v[40:43], v[80:83], v[192:195]
    ds_read_b128 v[80:83], v5 offset:8192
    v_mfma_f32_16x16x32_bf16 v[196:199], v[24:27], v[84:87], v[196:199]
    v_add_u32 v16, s50, v11
    v_mfma_f32_16x16x32_bf16 v[200:203], v[28:31], v[84:87], v[200:203]
    v_add_u32 v17, s50, v12
    v_mfma_f32_16x16x32_bf16 v[204:207], v[32:35], v[84:87], v[204:207]
    v_add_u32 v18, s50, v13
    v_mfma_f32_16x16x32_bf16 v[208:211], v[36:39], v[84:87], v[208:211]
    v_add_u32 v19, s52, v14
    v_mfma_f32_16x16x32_bf16 v[212:215], v[40:43], v[84:87], v[212:215]
    ds_read_b128 v[84:87], v5 offset:10240
    v_mfma_f32_16x16x32_bf16 v[216:219], v[24:27], v[88:91], v[216:219]
    v_add_u32 v4, s51, v20
    v_mfma_f32_16x16x32_bf16 v[220:223], v[28:31], v[88:91], v[220:223]
    ds_read_b128 v[6:9], v3
    v_mfma_f32_16x16x32_bf16 v[224:227], v[32:35], v[88:91], v[224:227]
    v_mfma_f32_16x16x32_bf16 v[228:231], v[36:39], v[88:91], v[228:231]
    v_mfma_f32_16x16x32_bf16 v[232:235], v[40:43], v[88:91], v[232:235]
    ds_read_b128 v[88:91], v5 offset:12288
    v_mfma_f32_16x16x32_bf16 v[236:239], v[24:27], v[92:95], v[236:239]
    v_mfma_f32_16x16x32_bf16 v[240:243], v[28:31], v[92:95], v[240:243]
    s_waitcnt lgkmcnt(1)
    v_min3_u32 v6, v6, v7, v8
    v_mfma_f32_16x16x32_bf16 v[244:247], v[32:35], v[92:95], v[244:247]
    v_min_u32 v6, v6, v9
    v_mfma_f32_16x16x32_bf16 v[248:251], v[36:39], v[92:95], v[248:251]
    v_readfirstlane_b32 s59, v6
    v_mfma_f32_16x16x32_bf16 v[252:255], v[40:43], v[92:95], v[252:255]
    ds_read_b128 v[92:95], v5 offset:14336
    s_cmp_ge_i32 s59, s58
    s_cbranch_scc0 L_g_slow1
L_g_go1:
    s_waitcnt lgkmcnt(2)
    v_mfma_f32_16x16x32_bf16 v[96:99], v[44:47], v[64:67], v[96:99]
    ds_read_b64_tr_b16 v[24:25], v15 offset:0
    v_mfma_f32_16x16x32_bf16 v[100:103], v[48:51], v[64:67], v[100:103]
    s_add_u32 s54, s54, 4
    v_mfma_f32_16x16x32_bf16 v[104:107], v[52:55], v[64:67], v[104:107]
    ds_read_b64_tr_b16 v[26:27], v15 offset:512
    v_mfma_f32_16x16x32_bf16 v[108:111], v[56:59], v[64:67], v[108:111]
    v_mfma_f32_16x16x32_bf16 v[112:115], v[60:63], v[64:67], v[112:115]
    ds_read_b128 v[64:67], v4 offset:0
    v_mfma_f32_16x16x32_bf16 v[116:119], v[44:47], v[68:71], v[116:119]
    ds_read_b64_tr_b16 v[28:29], v16 offset:0
    v_mfma_f32_16x16x32_bf16 v[120:123], v[48:51], v[68:71], v[120:123]
    s_add_u32 s58, s58, 1
    v_mfma_f32_16x16x32_bf16 v[124:127], v[52:55], v[68:71], v[124:127]
    ds_read_b64_tr_b16 v[30:31], v16 offset:512
    v_mfma_f32_16x16x32_bf16 v[128:131], v[56:59], v[68:71], v[128:131]
    s_min_u32 s58, s58, 20
    v_mfma_f32_16x16x32_bf16 v[132:135], v[60:63], v[68:71], v[132:135]
    ds_read_b128 v[68:71], v4 offset:2048
    s_waitcnt lgkmcnt(6)
    v_mfma_f32_16x16x32_bf16 v[136:139], v[44:47], v[72:75], v[136:139]
    ds_read_b64_tr_b16 v[32:33], v17 offset:0
    v_mfma_f32_16x16x32_bf16 v[140:143], v[48:51], v[72:75], v[140:143]
    buffer_load_dword v0, s[44:47], s54 offen lds
    v_mfma_f32_16x16x32_bf16 v[144:147], v[52:55], v[72:75], v[144:147]
    ds_read_b64_tr_b16 v[34:35], v17 offset:512
    v_mfma_f32_16x16x32_bf16 v[148:151], v[56:59], v[72:75], v[148:151]
    s_add_u32 s50, s50, 20480
    s_cmp_ge_u32 s50, 151552
    v_mfma_f32_16x16x32_bf16 v[152:155], v[60:63], v[72:75], v[152:155]
    ds_read_b128 v[72:75], v4 offset:4096
    v_mfma_f32_16x16x32_bf16 v[156:159], v[44:47], v[76:79], v[156:159]
    ds_read_b64_tr_b16 v[36:37], v18 offset:0
    v_mfma_f32_16x16x32_bf16 v[160:163], v[48:51], v[76:79], v[160:163]
    s_cselect_b32 s50, 49152, s50
    s_add_u32 s52, s52, s53
    v_mfma_f32_16x16x32_bf16 v[164:167], v[52:55], v[76:79], v[164:167]
    ds_read_b64_tr_b16 v[38:39], v18 offset:512
    v_mfma_f32_16x16x32_bf16 v[168:171], v[56:59], v[76:79], v[168:171]
    s_cmp_ge_u32 s52, s57
    s_cselect_b32 s52, 49152, s52
    v_mfma_f32_16x16x32_bf16 v[172:175], v[60:63], v[76:79], v[172:175]
    ds_read_b128 v[76:79], v4 offset:6144
    v_mfma_f32_16x16x32_bf16 v[176:179], v[44:47], v[80:83], v[176:179]
    ds_read_b64_tr_b16 v[40:41], v19 offset:0
    v_mfma_f32_16x16x32_bf16 v[180:183], v[48:51], v[80:83], v[180:183]
    v_mfma_f32_16x16x32_bf16 v[184:187], v[52:55], v[80:83], v[184:187]
    ds_read_b64_tr_b16 v[42:43], v19 offset:512
    v_mfma_f32_16x16x32_bf16 v[188:191], v[56:59], v[80:83], v[188:191]
    v_add_u32 v15, s50, v10
    v_mfma_f32_16x16x32_bf16 v[192:195], v[60:63], v[80:83], v[192:195]
    ds_read_b128 v[80:83], v4 offset:8192
    v_mfma_f32_16x16x32_bf16 v[196:199], v[44:47], v[84:87], v[196:199]
    v_add_u32 v16, s50, v11
    v_mfma_f32_16x16x32_bf16 v[200:203], v[48:51], v[84:87], v[200:203]
    v_add_u32 v17, s50, v12
    v_mfma_f32_16x16x32_bf16 v[204:207], v[52:55], v[84:87], v[204:207]
    v_add_u32 v18, s50, v13
    v_mfma_f32_16x16x32_bf16 v[208:211], v[56:59], v[84:87], v[208:211]
    v_add_u32 v19, s52, v14
    v_mfma_f32_16x16x32_bf16 v[212:215], v[60:63], v[84:87], v[212:215]
    ds_read_b128 v[84:87], v4 offset:10240
    v_mfma_f32_16x16x32_bf16 v[216:219], v[44:47], v[88:91], v[216:219]
    v_add_u32 v5, s51, v21
    v_mfma_f32_16x16x32_bf16 v[220:223], v[48:51], v[88:91], v[220:223]
    ds_read_b128 v[6:9], v3
    v_mfma_f32_16x16x32_bf16 v[224:227], v[52:55], v[88:91], v[224:227]
    v_mfma_f32_16x16x32_bf16 v[228:231], v[56:59], v[88:91], v[228:231]
    v_mfma_f32_16x16x32_bf16 v[232:235], v[60:63], v[88:91], v[232:235]
    ds_read_b128 v[88:91], v4 offset:12288
    v_mfma_f32_16x16x32_bf16 v[236:239], v[44:47], v[92:95], v[236:239]
    s_cmp_lt_u32 s54, 80
    v_mfma_f32_16x16x32_bf16 v[240:243], v[48:51], v[92:95], v[240:243]
    s_waitcnt lgkmcnt(1)
    v_min3_u32 v6, v6, v7, v8
    v_mfma_f32_16x16x32_bf16 v[244:247], v[52:55], v[92:95], v[244:247]
    v_min_u32 v6, v6, v9
    s_cbranch_scc0 L_g_last
    v_mfma_f32_16x16x32_bf16 v[248:251], v[56:59], v[92:95], v[248:251]
    v_readfirstlane_b32 s59, v6
    v_mfma_f32_16x16x32_bf16 v[252:255], v[60:63], v[92:95], v[252:255]
    ds_read_b128 v[92:95], v4 offset:14336
    s_cmp_ge_i32 s59, s58
    s_cbranch_scc1 L_g_go0
L_g_slow0:
    s_mov_b32 s96, 0
L_lw_54:
    ds_read_b128 v[6:9], v3 offset:0
    s_waitcnt lgkmcnt(0)
    v_min3_u32 v6, v6, v7, v8
    v_min_u32 v6, v6, v9
    s_nop 0
    v_readfirstlane_b32 s59, v6
    s_cmp_ge_i32 s59, s58
    s_cbranch_scc1 L_lwd_55
    s_sleep 1
    s_add_u32 s96, s96, 1
    s_cmp_lt_u32 s96, 2097152
    s_cbranch_scc1 L_lw_54
L_lwd_55:
    s_branch L_g_go0
L_g_slow1:
    s_mov_b32 s96, 0
L_lw_56:
    ds_read_b128 v[6:9], v3 offset:0
    s_waitcnt lgkmcnt(0)
    v_min3_u32 v6, v6, v7, v8
    v_min_u32 v6, v6, v9
    s_nop 0
    v_readfirstlane_b32 s59, v6
    s_cmp_ge_i32 s59, s58
    s_cbranch_scc1 L_lwd_57
    s_sleep 1
    s_add_u32 s96, s96, 1
    s_cmp_lt_u32 s96, 2097152
    s_cbranch_scc1 L_lw_56
L_lwd_57:
    s_branch L_g_go1
L_g_last:
    v_mfma_f32_16x16x32_bf16 v[248:251], v[56:59], v[92:95], v[248:251]
    v_mfma_f32_16x16x32_bf16 v[252:255], v[60:63], v[92:95], v[252:255]
    s_waitcnt lgkmcnt(0)
    s_nop 6
    v_pk_mul_f32 v[96:97], v[96:97], s[62:63]
    v_pk_mul_f32 v[98:99], v[98:99], s[62:63]
    v_pk_mul_f32 v[100:101], v[100:101], s[62:63]
    v_pk_mul_f32 v[102:103], v[102:103], s[62:63]
    v_exp_f32 v96, v96
    v_exp_f32 v97, v97
    v_exp_f32 v98, v98
    v_exp_f32 v99, v99
    v_exp_f32 v100, v100
    v_exp_f32 v101, v101
    v_exp_f32 v102, v102
    v_exp_f32 v103, v103
    v_pk_add_f32 v[96:97], v[96:97], s[64:65]
    v_pk_add_f32 v[98:99], v[98:99], s[64:65]
    v_pk_add_f32 v[100:101], v[100:101], s[64:65]
    v_pk_add_f32 v[102:103], v[102:103], s[64:65]
    v_rcp_f32 v96, v96
    v_rcp_f32 v97, v97
    v_rcp_f32 v98, v98
    v_rcp_f32 v99, v99
    v_rcp_f32 v100, v100
    v_rcp_f32 v101, v101
    v_rcp_f32 v102, v102
    v_rcp_f32 v103, v103
    v_pk_mul_f32 v[104:105], v[104:105], v[96:97]
    v_pk_mul_f32 v[106:107], v[106:107], v[98:99]
    v_pk_mul_f32 v[108:109], v[108:109], v[100:101]
    v_pk_mul_f32 v[110:111], v[110:111], v[102:103]
    v_cvt_pk_bf16_f32 v96, v104, v105
    v_cvt_pk_bf16_f32 v97, v106, v107
    v_cvt_pk_bf16_f32 v98, v108, v109
    v_cvt_pk_bf16_f32 v99, v110, v111
    buffer_store_dwordx4 v[96:99], v22, s[40:43], s70 offen offset:0 sc1
    v_pk_mul_f32 v[116:117], v[116:117], s[62:63]
    v_pk_mul_f32 v[118:119], v[118:119], s[62:63]
    v_pk_mul_f32 v[120:121], v[120:121], s[62:63]
    v_pk_mul_f32 v[122:123], v[122:123], s[62:63]
    v_exp_f32 v116, v116
    v_exp_f32 v117, v117
    v_exp_f32 v118, v118
    v_exp_f32 v119, v119
    v_exp_f32 v120, v120
    v_exp_f32 v121, v121
    v_exp_f32 v122, v122
    v_exp_f32 v123, v123
    v_pk_add_f32 v[116:117], v[116:117], s[64:65]
    v_pk_add_f32 v[118:119], v[118:119], s[64:65]
    v_pk_add_f32 v[120:121], v[120:121], s[64:65]
    v_pk_add_f32 v[122:123], v[122:123], s[64:65]
    v_rcp_f32 v116, v116
    v_rcp_f32 v117, v117
    v_rcp_f32 v118, v118
    v_rcp_f32 v119, v119
    v_rcp_f32 v120, v120
    v_rcp_f32 v121, v121
    v_rcp_f32 v122, v122
    v_rcp_f32 v123, v123
    v_pk_mul_f32 v[124:125], v[124:125], v[116:117]
    v_pk_mul_f32 v[126:127], v[126:127], v[118:119]
    v_pk_mul_f32 v[128:129], v[128:129], v[120:121]
    v_pk_mul_f32 v[130:131], v[130:131], v[122:123]
    v_cvt_pk_bf16_f32 v116, v124, v125
    v_cvt_pk_bf16_f32 v117, v126, v127
    v_cvt_pk_bf16_f32 v118, v128, v129
    v_cvt_pk_bf16_f32 v119, v130, v131
    buffer_store_dwordx4 v[116:119], v22, s[40:43], s70 offen offset:1024 sc1
    v_pk_mul_f32 v[136:137], v[136:137], s[62:63]
    v_pk_mul_f32 v[138:139], v[138:139], s[62:63]
    v_pk_mul_f32 v[140:141], v[140:141], s[62:63]
    v_pk_mul_f32 v[142:143], v[142:143], s[62:63]
    v_exp_f32 v136, v136
    v_exp_f32 v137, v137
    v_exp_f32 v138, v138
    v_exp_f32 v139, v139
    v_exp_f32 v140, v140
    v_exp_f32 v141, v141
    v_exp_f32 v142, v142
    v_exp_f32 v143, v143
    v_pk_add_f32 v[136:137], v[136:137], s[64:65]
    v_pk_add_f32 v[138:139], v[138:139], s[64:65]
    v_pk_add_f32 v[140:141], v[140:141], s[64:65]
    v_pk_add_f32 v[142:143], v[142:143], s[64:65]
    v_rcp_f32 v136, v136
    v_rcp_f32 v137, v137
    v_rcp_f32 v138, v138
    v_rcp_f32 v139, v139
    v_rcp_f32 v140, v140
    v_rcp_f32 v141, v141
    v_rcp_f32 v142, v142
    v_rcp_f32 v143, v143
    v_pk_mul_f32 v[144:145], v[144:145], v[136:137]
    v_pk_mul_f32 v[146:147], v[146:147], v[138:139]
    v_pk_mul_f32 v[148:149], v[148:149], v[140:141]
    v_pk_mul_f32 v[150:151], v[150:151], v[142:143]
    v_cvt_pk_bf16_f32 v136, v144, v145
    v_cvt_pk_bf16_f32 v137, v146, v147
    v_cvt_pk_bf16_f32 v138, v148, v149
    v_cvt_pk_bf16_f32 v139, v150, v151
    buffer_store_dwordx4 v[136:139], v22, s[40:43], s70 offen offset:2048 sc1
    v_pk_mul_f32 v[156:157], v[156:157], s[62:63]
    v_pk_mul_f32 v[158:159], v[158:159], s[62:63]
    v_pk_mul_f32 v[160:161], v[160:161], s[62:63]
    v_pk_mul_f32 v[162:163], v[162:163], s[62:63]
    v_exp_f32 v156, v156
    v_exp_f32 v157, v157
    v_exp_f32 v158, v158
    v_exp_f32 v159, v159
    v_exp_f32 v160, v160
    v_exp_f32 v161, v161
    v_exp_f32 v162, v162
    v_exp_f32 v163, v163
    v_pk_add_f32 v[156:157], v[156:157], s[64:65]
    v_pk_add_f32 v[158:159], v[158:159], s[64:65]
    v_pk_add_f32 v[160:161], v[160:161], s[64:65]
    v_pk_add_f32 v[162:163], v[162:163], s[64:65]
    v_rcp_f32 v156, v156
    v_rcp_f32 v157, v157
    v_rcp_f32 v158, v158
    v_rcp_f32 v159, v159
    v_rcp_f32 v160, v160
    v_rcp_f32 v161, v161
    v_rcp_f32 v162, v162
    v_rcp_f32 v163, v163
    v_pk_mul_f32 v[164:165], v[164:165], v[156:157]
    v_pk_mul_f32 v[166:167], v[166:167], v[158:159]
    v_pk_mul_f32 v[168:169], v[168:169], v[160:161]
    v_pk_mul_f32 v[170:171], v[170:171], v[162:163]
    v_cvt_pk_bf16_f32 v156, v164, v165
    v_cvt_pk_bf16_f32 v157, v166, v167
    v_cvt_pk_bf16_f32 v158, v168, v169
    v_cvt_pk_bf16_f32 v159, v170, v171
    buffer_store_dwordx4 v[156:159], v22, s[40:43], s70 offen offset:3072 sc1
    v_pk_mul_f32 v[176:177], v[176:177], s[62:63]
    v_pk_mul_f32 v[178:179], v[178:179], s[62:63]
    v_pk_mul_f32 v[180:181], v[180:181], s[62:63]
    v_pk_mul_f32 v[182:183], v[182:183], s[62:63]
    v_exp_f32 v176, v176
    v_exp_f32 v177, v177
    v_exp_f32 v178, v178
    v_exp_f32 v179, v179
    v_exp_f32 v180, v180
    v_exp_f32 v181, v181
    v_exp_f32 v182, v182
    v_exp_f32 v183, v183
    v_pk_add_f32 v[176:177], v[176:177], s[64:65]
    v_pk_add_f32 v[178:179], v[178:179], s[64:65]
    v_pk_add_f32 v[180:181], v[180:181], s[64:65]
    v_pk_add_f32 v[182:183], v[182:183], s[64:65]
    v_rcp_f32 v176, v176
    v_rcp_f32 v177, v177
    v_rcp_f32 v178, v178
    v_rcp_f32 v179, v179
    v_rcp_f32 v180, v180
    v_rcp_f32 v181, v181
    v_rcp_f32 v182, v182
    v_rcp_f32 v183, v183
    v_pk_mul_f32 v[184:185], v[184:185], v[176:177]
    v_pk_mul_f32 v[186:187], v[186:187], v[178:179]
    v_pk_mul_f32 v[188:189], v[188:189], v[180:181]
    v_pk_mul_f32 v[190:191], v[190:191], v[182:183]
    v_cvt_pk_bf16_f32 v176, v184, v185
    v_cvt_pk_bf16_f32 v177, v186, v187
    v_cvt_pk_bf16_f32 v178, v188, v189
    v_cvt_pk_bf16_f32 v179, v190, v191
    buffer_store_dwordx4 v[176:179], v22, s[40:43], s71 offen offset:0 sc1
    v_pk_mul_f32 v[196:197], v[196:197], s[62:63]
    v_pk_mul_f32 v[198:199], v[198:199], s[62:63]
    v_pk_mul_f32 v[200:201], v[200:201], s[62:63]
    v_pk_mul_f32 v[202:203], v[202:203], s[62:63]
    v_exp_f32 v196, v196
    v_exp_f32 v197, v197
    v_exp_f32 v198, v198
    v_exp_f32 v199, v199
    v_exp_f32 v200, v200
    v_exp_f32 v201, v201
    v_exp_f32 v202, v202
    v_exp_f32 v203, v203
    v_pk_add_f32 v[196:197], v[196:197], s[64:65]
    v_pk_add_f32 v[198:199], v[198:199], s[64:65]
    v_pk_add_f32 v[200:201], v[200:201], s[64:65]
    v_pk_add_f32 v[202:203], v[202:203], s[64:65]
    v_rcp_f32 v196, v196
    v_rcp_f32 v197, v197
    v_rcp_f32 v198, v198
    v_rcp_f32 v199, v199
    v_rcp_f32 v200, v200
    v_rcp_f32 v201, v201
    v_rcp_f32 v202, v202
    v_rcp_f32 v203, v203
    v_pk_mul_f32 v[204:205], v[204:205], v[196:197]
    v_pk_mul_f32 v[206:207], v[206:207], v[198:199]
    v_pk_mul_f32 v[208:209], v[208:209], v[200:201]
    v_pk_mul_f32 v[210:211], v[210:211], v[202:203]
    v_cvt_pk_bf16_f32 v196, v204, v205
    v_cvt_pk_bf16_f32 v197, v206, v207
    v_cvt_pk_bf16_f32 v198, v208, v209
    v_cvt_pk_bf16_f32 v199, v210, v211
    buffer_store_dwordx4 v[196:199], v22, s[40:43], s71 offen offset:1024 sc1
    v_pk_mul_f32 v[216:217], v[216:217], s[62:63]
    v_pk_mul_f32 v[218:219], v[218:219], s[62:63]
    v_pk_mul_f32 v[220:221], v[220:221], s[62:63]
    v_pk_mul_f32 v[222:223], v[222:223], s[62:63]
    v_exp_f32 v216, v216
    v_exp_f32 v217, v217
    v_exp_f32 v218, v218
    v_exp_f32 v219, v219
    v_exp_f32 v220, v220
    v_exp_f32 v221, v221
    v_exp_f32 v222, v222
    v_exp_f32 v223, v223
    v_pk_add_f32 v[216:217], v[216:217], s[64:65]
    v_pk_add_f32 v[218:219], v[218:219], s[64:65]
    v_pk_add_f32 v[220:221], v[220:221], s[64:65]
    v_pk_add_f32 v[222:223], v[222:223], s[64:65]
    v_rcp_f32 v216, v216
    v_rcp_f32 v217, v217
    v_rcp_f32 v218, v218
    v_rcp_f32 v219, v219
    v_rcp_f32 v220, v220
    v_rcp_f32 v221, v221
    v_rcp_f32 v222, v222
    v_rcp_f32 v223, v223
    v_pk_mul_f32 v[224:225], v[224:225], v[216:217]
    v_pk_mul_f32 v[226:227], v[226:227], v[218:219]
    v_pk_mul_f32 v[228:229], v[228:229], v[220:221]
    v_pk_mul_f32 v[230:231], v[230:231], v[222:223]
    v_cvt_pk_bf16_f32 v216, v224, v225
    v_cvt_pk_bf16_f32 v217, v226, v227
    v_cvt_pk_bf16_f32 v218, v228, v229
    v_cvt_pk_bf16_f32 v219, v230, v231
    buffer_store_dwordx4 v[216:219], v22, s[40:43], s71 offen offset:2048 sc1
    v_pk_mul_f32 v[236:237], v[236:237], s[62:63]
    v_pk_mul_f32 v[238:239], v[238:239], s[62:63]
    v_pk_mul_f32 v[240:241], v[240:241], s[62:63]
    v_pk_mul_f32 v[242:243], v[242:243], s[62:63]
    v_exp_f32 v236, v236
    v_exp_f32 v237, v237
    v_exp_f32 v238, v238
    v_exp_f32 v239, v239
    v_exp_f32 v240, v240
    v_exp_f32 v241, v241
    v_exp_f32 v242, v242
    v_exp_f32 v243, v243
    v_pk_add_f32 v[236:237], v[236:237], s[64:65]
    v_pk_add_f32 v[238:239], v[238:239], s[64:65]
    v_pk_add_f32 v[240:241], v[240:241], s[64:65]
    v_pk_add_f32 v[242:243], v[242:243], s[64:65]
    v_rcp_f32 v236, v236
    v_rcp_f32 v237, v237
    v_rcp_f32 v238, v238
    v_rcp_f32 v239, v239
    v_rcp_f32 v240, v240
    v_rcp_f32 v241, v241
    v_rcp_f32 v242, v242
    v_rcp_f32 v243, v243
    v_pk_mul_f32 v[244:245], v[244:245], v[236:237]
    v_pk_mul_f32 v[246:247], v[246:247], v[238:239]
    v_pk_mul_f32 v[248:249], v[248:249], v[240:241]
    v_pk_mul_f32 v[250:251], v[250:251], v[242:243]
    v_cvt_pk_bf16_f32 v236, v244, v245
    v_cvt_pk_bf16_f32 v237, v246, v247
    v_cvt_pk_bf16_f32 v238, v248, v249
    v_cvt_pk_bf16_f32 v239, v250, v251
    buffer_store_dwordx4 v[236:239], v22, s[40:43], s71 offen offset:3072 sc1
    s_cmp_lg_u32 s91, 0
    s_cbranch_scc1 L_gc_epi
    v_pk_mul_f32 v[24:25], v[112:113], s[60:61]
    v_pk_mul_f32 v[26:27], v[114:115], s[60:61]
    v_exp_f32 v24, v24 clamp
    v_exp_f32 v25, v25 clamp
    v_exp_f32 v26, v26 clamp
    v_exp_f32 v27, v27 clamp
    v_max_f32 v112, s66, v112
    v_max_f32 v113, s66, v113
    v_max_f32 v114, s66, v114
    v_max_f32 v115, s66, v115
    v_pk_add_f32 v[112:113], v[112:113], v[24:25]
    v_pk_add_f32 v[114:115], v[114:115], v[26:27]
    v_pk_mul_f32 v[28:29], v[132:133], s[60:61]
    v_pk_mul_f32 v[30:31], v[134:135], s[60:61]
    v_exp_f32 v28, v28 clamp
    v_exp_f32 v29, v29 clamp
    v_exp_f32 v30, v30 clamp
    v_exp_f32 v31, v31 clamp
    v_max_f32 v132, s66, v132
    v_max_f32 v133, s66, v133
    v_max_f32 v134, s66, v134
    v_max_f32 v135, s66, v135
    v_pk_add_f32 v[132:133], v[132:133], v[28:29]
    v_pk_add_f32 v[134:135], v[134:135], v[30:31]
    v_cvt_pk_bf16_f32 v112, v112, v113
    v_cvt_pk_bf16_f32 v113, v114, v115
    v_cvt_pk_bf16_f32 v114, v132, v133
    v_cvt_pk_bf16_f32 v115, v134, v135
    s_nop 1
    v_permlane16_swap_b32 v112, v114
    v_permlane16_swap_b32 v113, v115
    buffer_store_dwordx4 v[112:115], v23, s[40:43], s72 offen offset:0 sc1
    v_pk_mul_f32 v[32:33], v[152:153], s[60:61]
    v_pk_mul_f32 v[34:35], v[154:155], s[60:61]
    v_exp_f32 v32, v32 clamp
    v_exp_f32 v33, v33 clamp
    v_exp_f32 v34, v34 clamp
    v_exp_f32 v35, v35 clamp
    v_max_f32 v152, s66, v152
    v_max_f32 v153, s66, v153
    v_max_f32 v154, s66, v154
    v_max_f32 v155, s66, v155
    v_pk_add_f32 v[152:153], v[152:153], v[32:33]
    v_pk_add_f32 v[154:155], v[154:155], v[34:35]
    v_pk_mul_f32 v[36:37], v[172:173], s[60:61]
    v_pk_mul_f32 v[38:39], v[174:175], s[60:61]
    v_exp_f32 v36, v36 clamp
    v_exp_f32 v37, v37 clamp
    v_exp_f32 v38, v38 clamp
    v_exp_f32 v39, v39 clamp
    v_max_f32 v172, s66, v172
    v_max_f32 v173, s66, v173
    v_max_f32 v174, s66, v174
    v_max_f32 v175, s66, v175
    v_pk_add_f32 v[172:173], v[172:173], v[36:37]
    v_pk_add_f32 v[174:175], v[174:175], v[38:39]
    v_cvt_pk_bf16_f32 v152, v152, v153
    v_cvt_pk_bf16_f32 v153, v154, v155
    v_cvt_pk_bf16_f32 v154, v172, v173
    v_cvt_pk_bf16_f32 v155, v174, v175
    s_nop 1
    v_permlane16_swap_b32 v152, v154
    v_permlane16_swap_b32 v153, v155
    buffer_store_dwordx4 v[152:155], v23, s[40:43], s72 offen offset:2048 sc1
    v_pk_mul_f32 v[24:25], v[192:193], s[60:61]
    v_pk_mul_f32 v[26:27], v[194:195], s[60:61]
    v_exp_f32 v24, v24 clamp
    v_exp_f32 v25, v25 clamp
    v_exp_f32 v26, v26 clamp
    v_exp_f32 v27, v27 clamp
    v_max_f32 v192, s66, v192
    v_max_f32 v193, s66, v193
    v_max_f32 v194, s66, v194
    v_max_f32 v195, s66, v195
    v_pk_add_f32 v[192:193], v[192:193], v[24:25]
    v_pk_add_f32 v[194:195], v[194:195], v[26:27]
    v_pk_mul_f32 v[28:29], v[212:213], s[60:61]
    v_pk_mul_f32 v[30:31], v[214:215], s[60:61]
    v_exp_f32 v28, v28 clamp
    v_exp_f32 v29, v29 clamp
    v_exp_f32 v30, v30 clamp
    v_exp_f32 v31, v31 clamp
    v_max_f32 v212, s66, v212
    v_max_f32 v213, s66, v213
    v_max_f32 v214, s66, v214
    v_max_f32 v215, s66, v215
    v_pk_add_f32 v[212:213], v[212:213], v[28:29]
    v_pk_add_f32 v[214:215], v[214:215], v[30:31]
    v_cvt_pk_bf16_f32 v192, v192, v193
    v_cvt_pk_bf16_f32 v193, v194, v195
    v_cvt_pk_bf16_f32 v194, v212, v213
    v_cvt_pk_bf16_f32 v195, v214, v215
    s_nop 1
    v_permlane16_swap_b32 v192, v194
    v_permlane16_swap_b32 v193, v195
    buffer_store_dwordx4 v[192:195], v23, s[40:43], s73 offen offset:0 sc1
    v_pk_mul_f32 v[32:33], v[232:233], s[60:61]
    v_pk_mul_f32 v[34:35], v[234:235], s[60:61]
    v_exp_f32 v32, v32 clamp
    v_exp_f32 v33, v33 clamp
    v_exp_f32 v34, v34 clamp
    v_exp_f32 v35, v35 clamp
    v_max_f32 v232, s66, v232
    v_max_f32 v233, s66, v233
    v_max_f32 v234, s66, v234
    v_max_f32 v235, s66, v235
    v_pk_add_f32 v[232:233], v[232:233], v[32:33]
    v_pk_add_f32 v[234:235], v[234:235], v[34:35]
    v_pk_mul_f32 v[36:37], v[252:253], s[60:61]
    v_pk_mul_f32 v[38:39], v[254:255], s[60:61]
    v_exp_f32 v36, v36 clamp
    v_exp_f32 v37, v37 clamp
    v_exp_f32 v38, v38 clamp
    v_exp_f32 v39, v39 clamp
    v_max_f32 v252, s66, v252
    v_max_f32 v253, s66, v253
    v_max_f32 v254, s66, v254
    v_max_f32 v255, s66, v255
    v_pk_add_f32 v[252:253], v[252:253], v[36:37]
    v_pk_add_f32 v[254:255], v[254:255], v[38:39]
    v_cvt_pk_bf16_f32 v232, v232, v233
    v_cvt_pk_bf16_f32 v233, v234, v235
    v_cvt_pk_bf16_f32 v234, v252, v253
    v_cvt_pk_bf16_f32 v235, v254, v255
    s_nop 1
    v_permlane16_swap_b32 v232, v234
    v_permlane16_swap_b32 v233, v235
    buffer_store_dwordx4 v[232:235], v23, s[40:43], s73 offen offset:2048 sc1
    s_branch L_p1_done
L_gc_epi:
    v_and_b32 v8, 15, v2
    v_lshlrev_b32 v8, 2, v8
    s_lshl_b32 s48, s18, 9
    s_add_u32 s48, s48, 15728640
    s_lshl_b32 s49, s22, 2
    s_add_u32 s49, s49, s21
    s_cmp_eq_u32 s49, 40
    s_cselect_b32 s48, s48, 2147418112
    v_mul_f32 v112, s62, v112
    v_mul_f32 v132, s62, v132
    v_mul_f32 v152, s62, v152
    v_mul_f32 v172, s62, v172
    v_mul_f32 v192, s62, v192
    v_mul_f32 v212, s62, v212
    v_mul_f32 v232, s62, v232
    v_mul_f32 v252, s62, v252
    v_exp_f32 v112, v112
    v_exp_f32 v132, v132
    v_exp_f32 v152, v152
    v_exp_f32 v172, v172
    v_exp_f32 v192, v192
    v_exp_f32 v212, v212
    v_exp_f32 v232, v232
    v_exp_f32 v252, v252
    v_add_f32 v112, 1.0, v112
    v_add_f32 v132, 1.0, v132
    v_add_f32 v152, 1.0, v152
    v_add_f32 v172, 1.0, v172
    v_add_f32 v192, 1.0, v192
    v_add_f32 v212, 1.0, v212
    v_add_f32 v232, 1.0, v232
    v_add_f32 v252, 1.0, v252
    v_rcp_f32 v112, v112
    v_rcp_f32 v132, v132
    v_rcp_f32 v152, v152
    v_rcp_f32 v172, v172
    v_rcp_f32 v192, v192
    v_rcp_f32 v212, v212
    v_rcp_f32 v232, v232
    v_rcp_f32 v252, v252
    s_nop 0
    s_mov_b64 exec, 0xffff
    buffer_store_dword v112, v8, s[40:43], s48 offen offset:0 sc1
    buffer_store_dword v132, v8, s[40:43], s48 offen offset:64 sc1
    buffer_store_dword v152, v8, s[40:43], s48 offen offset:128 sc1
    buffer_store_dword v172, v8, s[40:43], s48 offen offset:192 sc1
    buffer_store_dword v192, v8, s[40:43], s48 offen offset:256 sc1
    buffer_store_dword v212, v8, s[40:43], s48 offen offset:320 sc1
    buffer_store_dword v232, v8, s[40:43], s48 offen offset:384 sc1
    buffer_store_dword v252, v8, s[40:43], s48 offen offset:448 sc1
    s_mov_b64 exec, -1
    s_branch L_p1_done
L_kv:
    s_mul_i32 s48, s21, 10
    s_and_b32 s49, s19, 1
    s_lshl_b32 s49, s49, 3
    s_sub_u32 s48, s48, s49
    v_mov_b32 v16, 0
    v_mov_b32 v17, 1
    v_add_u32 v15, s48, v5
    v_add_u32 v9, 40, v15
    v_cmp_gt_i32 vcc, 0, v15
    s_nop 1
    v_cndmask_b32 v8, v15, v9, vcc
    v_lshrrev_b32 v9, 4, v8
    v_lshl_add_u32 v9, v16, 1, v9
    v_and_b32 v23, 15, v8
    v_lshl_add_u32 v22, v16, 3, v23
    v_cmp_gt_u32 vcc, 32, v8
    s_nop 1
    v_cndmask_b32 v9, 4, v9, vcc
    v_cndmask_b32 v23, v22, v23, vcc
    v_lshlrev_b32 v23, 3, v23
    v_xor_b32 v23, v23, v6
    v_lshlrev_b32 v22, 4, v16
    v_xor_b32 v23, v23, v22
    v_lshl_add_u32 v23, v9, 10, v23
    v_add_u32 v10, v23, v7
    v_add_u32 v9, 40, v15
    v_cmp_gt_i32 vcc, 0, v15
    s_nop 1
    v_cndmask_b32 v8, v15, v9, vcc
    v_lshrrev_b32 v9, 4, v8
    v_lshl_add_u32 v9, v17, 1, v9
    v_and_b32 v23, 15, v8
    v_lshl_add_u32 v22, v17, 3, v23
    v_cmp_gt_u32 vcc, 32, v8
    s_nop 1
    v_cndmask_b32 v9, 4, v9, vcc
    v_cndmask_b32 v23, v22, v23, vcc
    v_lshlrev_b32 v23, 3, v23
    v_xor_b32 v23, v23, v6
    v_lshlrev_b32 v22, 4, v17
    v_xor_b32 v23, v23, v22
    v_lshl_add_u32 v23, v9, 10, v23
    v_add_u32 v12, v23, v7
    v_add_u32 v15, 5, v15
    v_add_u32 v9, 40, v15
    v_cmp_gt_i32 vcc, 0, v15
    s_nop 1
    v_cndmask_b32 v8, v15, v9, vcc
    v_lshrrev_b32 v9, 4, v8
    v_lshl_add_u32 v9, v16, 1, v9
    v_and_b32 v23, 15, v8
    v_lshl_add_u32 v22, v16, 3, v23
    v_cmp_gt_u32 vcc, 32, v8
    s_nop 1
    v_cndmask_b32 v9, 4, v9, vcc
    v_cndmask_b32 v23, v22, v23, vcc
    v_lshlrev_b32 v23, 3, v23
    v_xor_b32 v23, v23, v6
    v_lshlrev_b32 v22, 4, v16
    v_xor_b32 v23, v23, v22
    v_lshl_add_u32 v23, v9, 10, v23
    v_add_u32 v11, v23, v7
    v_add_u32 v9, 40, v15
    v_cmp_gt_i32 vcc, 0, v15
    s_nop 1
    v_cndmask_b32 v8, v15, v9, vcc
    v_lshrrev_b32 v9, 4, v8
    v_lshl_add_u32 v9, v17, 1, v9
    v_and_b32 v23, 15, v8
    v_lshl_add_u32 v22, v17, 3, v23
    v_cmp_gt_u32 vcc, 32, v8
    s_nop 1
    v_cndmask_b32 v9, 4, v9, vcc
    v_cndmask_b32 v23, v22, v23, vcc
    v_lshlrev_b32 v23, 3, v23
    v_xor_b32 v23, v23, v6
    v_lshlrev_b32 v22, 4, v17
    v_xor_b32 v23, v23, v22
    v_lshl_add_u32 v23, v9, 10, v23
    v_add_u32 v13, v23, v7
    v_and_b32 v15, 1, v5
    v_mul_u32_u24 v15, 5, v15
    v_add3_u32 v15, v15, s48, 4
    v_lshrrev_b32 v16, 1, v5
    v_add_u32 v9, 40, v15
    v_cmp_gt_i32 vcc, 0, v15
    s_nop 1
    v_cndmask_b32 v8, v15, v9, vcc
    v_lshrrev_b32 v9, 4, v8
    v_lshl_add_u32 v9, v16, 1, v9
    v_and_b32 v23, 15, v8
    v_lshl_add_u32 v22, v16, 3, v23
    v_cmp_gt_u32 vcc, 32, v8
    s_nop 1
    v_cndmask_b32 v9, 4, v9, vcc
    v_cndmask_b32 v23, v22, v23, vcc
    v_lshlrev_b32 v23, 3, v23
    v_xor_b32 v23, v23, v6
    v_lshlrev_b32 v22, 4, v16
    v_xor_b32 v23, v23, v22
    v_lshl_add_u32 v23, v9, 10, v23
    v_add_u32 v14, v23, v7
    v_lshlrev_b32 v22, 4, v2
    v_lshlrev_b32 v23, 4, v3
    v_and_b32 v8, 15, v2
    v_cmp_gt_u32 s[68:69], 8, v8
    s_lshl_b32 s48, s19, 2
    s_add_u32 s48, s48, s21
    s_lshl_b32 s48, s48, 4
    s_add_u32 s48, s48, s18
    s_mul_i32 s70, s48, 3584
    s_add_u32 s70, s70, 12582912
    s_lshr_b32 s71, s21, 1
    s_mul_i32 s71, s71, 110592
    s_and_b32 s49, s21, 1
    s_lshl_b32 s49, s49, 12
    s_add_u32 s71, s71, s49
    s_add_u32 s71, s71, 40960
    v_mul_u32_u24 v23, 5, v8
    v_add_u32 v23, v23, v3
    v_lshlrev_b32 v23, 4, v23
    v_add_u32 v23, s71, v23
    s_mov_b32 s50, 49152
    s_mov_b32 s51, 0
    s_mov_b32 s54, 0
    v_add_u32 v15, s50, v10
    v_add_u32 v16, s50, v11
    v_add_u32 v17, s50, v12
    v_add_u32 v18, s50, v13
    v_add_u32 v19, s50, v14
    v_add_u32 v4, s51, v20
    v_add_u32 v5, s51, v21
    v_mov_b32 v3, 159744
    s_lshl_b32 s48, s21, 8
    s_add_u32 m0, s48, 160000
    v_mov_b32 v0, 2147418112
    v_writelane_b32 v0, 0, 0
    s_getpc_b64 s[44:45]
L_pc_58:
    s_add_u32 s44, s44, L_table-L_pc_58
    s_addc_u32 s45, s45, 0
    s_movk_i32 s46, 128
    s_mov_b32 s47, 0x20000
    s_mov_b32 s96, 0
L_lw_59:
    ds_read_b128 v[6:9], v3 offset:0
    s_waitcnt lgkmcnt(0)
    v_min3_u32 v6, v6, v7, v8
    v_min_u32 v6, v6, v9
    s_nop 0
    v_readfirstlane_b32 s59, v6
    s_cmp_ge_i32 s59, 1
    s_cbranch_scc1 L_lwd_60
    s_sleep 1
    s_add_u32 s96, s96, 1
    s_cmp_lt_u32 s96, 2097152
    s_cbranch_scc1 L_lw_59
L_lwd_60:
    s_waitcnt vmcnt(0)
    s_setprio 2
    ds_read_b64_tr_b16 v[24:25], v15 offset:0
    ds_read_b64_tr_b16 v[26:27], v15 offset:512
    ds_read_b64_tr_b16 v[28:29], v16 offset:0
    ds_read_b64_tr_b16 v[30:31], v16 offset:512
    ds_read_b64_tr_b16 v[32:33], v17 offset:0
    ds_read_b64_tr_b16 v[34:35], v17 offset:512
    ds_read_b64_tr_b16 v[36:37], v18 offset:0
    ds_read_b64_tr_b16 v[38:39], v18 offset:512
    ds_read_b64_tr_b16 v[40:41], v19 offset:0
    ds_read_b64_tr_b16 v[42:43], v19 offset:512
    s_waitcnt lgkmcnt(6)
    ds_read_b128 v[64:67], v4 offset:0
    ds_read_b128 v[68:71], v4 offset:2048
    ds_read_b128 v[72:75], v4 offset:4096
    ds_read_b128 v[76:79], v4 offset:6144
    ds_read_b128 v[80:83], v4 offset:8192
    ds_read_b128 v[84:87], v4 offset:10240
    ds_read_b128 v[88:91], v4 offset:12288
    ds_read_b128 v[92:95], v4 offset:14336
    s_add_u32 s50, s50, 20480
    s_cmp_ge_u32 s50, 151552
    s_cselect_b32 s50, 49152, s50
    v_add_u32 v15, s50, v10
    v_add_u32 v16, s50, v11
    v_add_u32 v17, s50, v12
    v_add_u32 v18, s50, v13
    v_add_u32 v19, s50, v14
    s_mov_b32 s58, 2
    s_cmp_ge_i32 s59, s58
    s_cbranch_scc0 L_kv_slow0
    .p2align 3
L_kv_go0:
    s_waitcnt lgkmcnt(2)
    v_mfma_f32_16x16x32_bf16 v[96:99], v[64:67], v[24:27], v[96:99]
    ds_read_b64_tr_b16 v[44:45], v15 offset:0
    v_mfma_f32_16x16x32_bf16 v[100:103], v[64:67], v[28:31], v[100:103]
    s_add_u32 s54, s54, 4
    v_mfma_f32_16x16x32_bf16 v[104:107], v[64:67], v[32:35], v[104:107]
    ds_read_b64_tr_b16 v[46:47], v15 offset:512
    v_mfma_f32_16x16x32_bf16 v[108:111], v[64:67], v[36:39], v[108:111]
    v_mfma_f32_16x16x32_bf16 v[112:115], v[64:67], v[40:43], v[112:115]
    ds_read_b128 v[64:67], v5 offset:0
    v_mfma_f32_16x16x32_bf16 v[116:119], v[68:71], v[24:27], v[116:119]
    ds_read_b64_tr_b16 v[48:49], v16 offset:0
    v_mfma_f32_16x16x32_bf16 v[120:123], v[68:71], v[28:31], v[120:123]
    s_add_u32 s58, s58, 1
    v_mfma_f32_16x16x32_bf16 v[124:127], v[68:71], v[32:35], v[124:127]
    ds_read_b64_tr_b16 v[50:51], v16 offset:512
    v_mfma_f32_16x16x32_bf16 v[128:131], v[68:71], v[36:39], v[128:131]
    s_min_u32 s58, s58, 20
    v_mfma_f32_16x16x32_bf16 v[132:135], v[68:71], v[40:43], v[132:135]
    ds_read_b128 v[68:71], v5 offset:2048
    s_waitcnt lgkmcnt(6)
    v_mfma_f32_16x16x32_bf16 v[136:139], v[72:75], v[24:27], v[136:139]
    ds_read_b64_tr_b16 v[52:53], v17 offset:0
    v_mfma_f32_16x16x32_bf16 v[140:143], v[72:75], v[28:31], v[140:143]
    buffer_load_dword v0, s[44:47], s54 offen lds
    v_mfma_f32_16x16x32_bf16 v[144:147], v[72:75], v[32:35], v[144:147]
    ds_read_b64_tr_b16 v[54:55], v17 offset:512
    v_mfma_f32_16x16x32_bf16 v[148:151], v[72:75], v[36:39], v[148:151]
    s_add_u32 s50, s50, 20480
    s_cmp_ge_u32 s50, 151552
    v_mfma_f32_16x16x32_bf16 v[152:155], v[72:75], v[40:43], v[152:155]
    ds_read_b128 v[72:75], v5 offset:4096
    v_mfma_f32_16x16x32_bf16 v[156:159], v[76:79], v[24:27], v[156:159]
    ds_read_b64_tr_b16 v[56:57], v18 offset:0
    v_mfma_f32_16x16x32_bf16 v[160:163], v[76:79], v[28:31], v[160:163]
    s_cselect_b32 s50, 49152, s50
    s_add_u32 s51, s51, 16384
    v_mfma_f32_16x16x32_bf16 v[164:167], v[76:79], v[32:35], v[164:167]
    ds_read_b64_tr_b16 v[58:59], v18 offset:512
    v_mfma_f32_16x16x32_bf16 v[168:171], v[76:79], v[36:39], v[168:171]
    s_cmp_ge_u32 s51, 49152
    s_cselect_b32 s51, 0, s51
    v_mfma_f32_16x16x32_bf16 v[172:175], v[76:79], v[40:43], v[172:175]
    ds_read_b128 v[76:79], v5 offset:6144
    v_mfma_f32_16x16x32_bf16 v[176:179], v[80:83], v[24:27], v[176:179]
    ds_read_b64_tr_b16 v[60:61], v19 offset:0
    v_mfma_f32_16x16x32_bf16 v[180:183], v[80:83], v[28:31], v[180:183]
    v_mfma_f32_16x16x32_bf16 v[184:187], v[80:83], v[32:35], v[184:187]
    ds_read_b64_tr_b16 v[62:63], v19 offset:512
    v_mfma_f32_16x16x32_bf16 v[188:191], v[80:83], v[36:39], v[188:191]
    v_add_u32 v15, s50, v10
    v_mfma_f32_16x16x32_bf16 v[192:195], v[80:83], v[40:43], v[192:195]
    ds_read_b128 v[80:83], v5 offset:8192
    v_mfma_f32_16x16x32_bf16 v[196:199], v[84:87], v[24:27], v[196:199]
    v_add_u32 v16, s50, v11
    v_mfma_f32_16x16x32_bf16 v[200:203], v[84:87], v[28:31], v[200:203]
    v_add_u32 v17, s50, v12
    v_mfma_f32_16x16x32_bf16 v[204:207], v[84:87], v[32:35], v[204:207]
    v_add_u32 v18, s50, v13
    v_mfma_f32_16x16x32_bf16 v[208:211], v[84:87], v[36:39], v[208:211]
    v_add_u32 v19, s50, v14
    v_mfma_f32_16x16x32_bf16 v[212:215], v[84:87], v[40:43], v[212:215]
    ds_read_b128 v[84:87], v5 offset:10240
    v_mfma_f32_16x16x32_bf16 v[216:219], v[88:91], v[24:27], v[216:219]
    v_add_u32 v4, s51, v20
    v_mfma_f32_16x16x32_bf16 v[220:223], v[88:91], v[28:31], v[220:223]
    ds_read_b128 v[6:9], v3
    v_mfma_f32_16x16x32_bf16 v[224:227], v[88:91], v[32:35], v[224:227]
    v_mfma_f32_16x16x32_bf16 v[228:231], v[88:91], v[36:39], v[228:231]
    v_mfma_f32_16x16x32_bf16 v[232:235], v[88:91], v[40:43], v[232:235]
    ds_read_b128 v[88:91], v5 offset:12288
    v_mfma_f32_16x16x32_bf16 v[236:239], v[92:95], v[24:27], v[236:239]
    v_mfma_f32_16x16x32_bf16 v[240:243], v[92:95], v[28:31], v[240:243]
    s_waitcnt lgkmcnt(1)
    v_min3_u32 v6, v6, v7, v8
    v_mfma_f32_16x16x32_bf16 v[244:247], v[92:95], v[32:35], v[244:247]
    v_min_u32 v6, v6, v9
    v_mfma_f32_16x16x32_bf16 v[248:251], v[92:95], v[36:39], v[248:251]
    v_readfirstlane_b32 s59, v6
    v_mfma_f32_16x16x32_bf16 v[252:255], v[92:95], v[40:43], v[252:255]
    ds_read_b128 v[92:95], v5 offset:14336
    s_cmp_ge_i32 s59, s58
    s_cbranch_scc0 L_kv_slow1
L_kv_go1:
    s_waitcnt lgkmcnt(2)
    v_mfma_f32_16x16x32_bf16 v[96:99], v[64:67], v[44:47], v[96:99]
    ds_read_b64_tr_b16 v[24:25], v15 offset:0
    v_mfma_f32_16x16x32_bf16 v[100:103], v[64:67], v[48:51], v[100:103]
    s_add_u32 s54, s54, 4
    v_mfma_f32_16x16x32_bf16 v[104:107], v[64:67], v[52:55], v[104:107]
    ds_read_b64_tr_b16 v[26:27], v15 offset:512
    v_mfma_f32_16x16x32_bf16 v[108:111], v[64:67], v[56:59], v[108:111]
    v_mfma_f32_16x16x32_bf16 v[112:115], v[64:67], v[60:63], v[112:115]
    ds_read_b128 v[64:67], v4 offset:0
    v_mfma_f32_16x16x32_bf16 v[116:119], v[68:71], v[44:47], v[116:119]
    ds_read_b64_tr_b16 v[28:29], v16 offset:0
    v_mfma_f32_16x16x32_bf16 v[120:123], v[68:71], v[48:51], v[120:123]
    s_add_u32 s58, s58, 1
    v_mfma_f32_16x16x32_bf16 v[124:127], v[68:71], v[52:55], v[124:127]
    ds_read_b64_tr_b16 v[30:31], v16 offset:512
    v_mfma_f32_16x16x32_bf16 v[128:131], v[68:71], v[56:59], v[128:131]
    s_min_u32 s58, s58, 20
    v_mfma_f32_16x16x32_bf16 v[132:135], v[68:71], v[60:63], v[132:135]
    ds_read_b128 v[68:71], v4 offset:2048
    s_waitcnt lgkmcnt(6)
    v_mfma_f32_16x16x32_bf16 v[136:139], v[72:75], v[44:47], v[136:139]
    ds_read_b64_tr_b16 v[32:33], v17 offset:0
    v_mfma_f32_16x16x32_bf16 v[140:143], v[72:75], v[48:51], v[140:143]
    buffer_load_dword v0, s[44:47], s54 offen lds
    v_mfma_f32_16x16x32_bf16 v[144:147], v[72:75], v[52:55], v[144:147]
    ds_read_b64_tr_b16 v[34:35], v17 offset:512
    v_mfma_f32_16x16x32_bf16 v[148:151], v[72:75], v[56:59], v[148:151]
    s_add_u32 s50, s50, 20480
    s_cmp_ge_u32 s50, 151552
    v_mfma_f32_16x16x32_bf16 v[152:155], v[72:75], v[60:63], v[152:155]
    ds_read_b128 v[72:75], v4 offset:4096
    v_mfma_f32_16x16x32_bf16 v[156:159], v[76:79], v[44:47], v[156:159]
    ds_read_b64_tr_b16 v[36:37], v18 offset:0
    v_mfma_f32_16x16x32_bf16 v[160:163], v[76:79], v[48:51], v[160:163]
    s_cselect_b32 s50, 49152, s50
    v_mfma_f32_16x16x32_bf16 v[164:167], v[76:79], v[52:55], v[164:167]
    ds_read_b64_tr_b16 v[38:39], v18 offset:512
    v_mfma_f32_16x16x32_bf16 v[168:171], v[76:79], v[56:59], v[168:171]
    v_mfma_f32_16x16x32_bf16 v[172:175], v[76:79], v[60:63], v[172:175]
    ds_read_b128 v[76:79], v4 offset:6144
    v_mfma_f32_16x16x32_bf16 v[176:179], v[80:83], v[44:47], v[176:179]
    ds_read_b64_tr_b16 v[40:41], v19 offset:0
    v_mfma_f32_16x16x32_bf16 v[180:183], v[80:83], v[48:51], v[180:183]
    v_mfma_f32_16x16x32_bf16 v[184:187], v[80:83], v[52:55], v[184:187]
    ds_read_b64_tr_b16 v[42:43], v19 offset:512
    v_mfma_f32_16x16x32_bf16 v[188:191], v[80:83], v[56:59], v[188:191]
    v_add_u32 v15, s50, v10
    v_mfma_f32_16x16x32_bf16 v[192:195], v[80:83], v[60:63], v[192:195]
    ds_read_b128 v[80:83], v4 offset:8192
    v_mfma_f32_16x16x32_bf16 v[196:199], v[84:87], v[44:47], v[196:199]
    v_add_u32 v16, s50, v11
    v_mfma_f32_16x16x32_bf16 v[200:203], v[84:87], v[48:51], v[200:203]
    v_add_u32 v17, s50, v12
    v_mfma_f32_16x16x32_bf16 v[204:207], v[84:87], v[52:55], v[204:207]
    v_add_u32 v18, s50, v13
    v_mfma_f32_16x16x32_bf16 v[208:211], v[84:87], v[56:59], v[208:211]
    v_add_u32 v19, s50, v14
    v_mfma_f32_16x16x32_bf16 v[212:215], v[84:87], v[60:63], v[212:215]
    ds_read_b128 v[84:87], v4 offset:10240
    v_mfma_f32_16x16x32_bf16 v[216:219], v[88:91], v[44:47], v[216:219]
    v_add_u32 v5, s51, v21
    v_mfma_f32_16x16x32_bf16 v[220:223], v[88:91], v[48:51], v[220:223]
    ds_read_b128 v[6:9], v3
    v_mfma_f32_16x16x32_bf16 v[224:227], v[88:91], v[52:55], v[224:227]
    v_mfma_f32_16x16x32_bf16 v[228:231], v[88:91], v[56:59], v[228:231]
    v_mfma_f32_16x16x32_bf16 v[232:235], v[88:91], v[60:63], v[232:235]
    ds_read_b128 v[88:91], v4 offset:12288
    v_mfma_f32_16x16x32_bf16 v[236:239], v[92:95], v[44:47], v[236:239]
    s_cmp_lt_u32 s54, 80
    v_mfma_f32_16x16x32_bf16 v[240:243], v[92:95], v[48:51], v[240:243]
    s_waitcnt lgkmcnt(1)
    v_min3_u32 v6, v6, v7, v8
    v_mfma_f32_16x16x32_bf16 v[244:247], v[92:95], v[52:55], v[244:247]
    v_min_u32 v6, v6, v9
    s_cbranch_scc0 L_kv_last
    v_mfma_f32_16x16x32_bf16 v[248:251], v[92:95], v[56:59], v[248:251]
    v_readfirstlane_b32 s59, v6
    v_mfma_f32_16x16x32_bf16 v[252:255], v[92:95], v[60:63], v[252:255]
    ds_read_b128 v[92:95], v4 offset:14336
    s_cmp_ge_i32 s59, s58
    s_cbranch_scc1 L_kv_go0
L_kv_slow0:
    s_mov_b32 s96, 0
L_lw_61:
    ds_read_b128 v[6:9], v3 offset:0
    s_waitcnt lgkmcnt(0)
    v_min3_u32 v6, v6, v7, v8
    v_min_u32 v6, v6, v9
    s_nop 0
    v_readfirstlane_b32 s59, v6
    s_cmp_ge_i32 s59, s58
    s_cbranch_scc1 L_lwd_62
    s_sleep 1
    s_add_u32 s96, s96, 1
    s_cmp_lt_u32 s96, 2097152
    s_cbranch_scc1 L_lw_61
L_lwd_62:
    s_branch L_kv_go0
L_kv_slow1:
    s_mov_b32 s96, 0
L_lw_63:
    ds_read_b128 v[6:9], v3 offset:0
    s_waitcnt lgkmcnt(0)
    v_min3_u32 v6, v6, v7, v8
    v_min_u32 v6, v6, v9
    s_nop 0
    v_readfirstlane_b32 s59, v6
    s_cmp_ge_i32 s59, s58
    s_cbranch_scc1 L_lwd_64
    s_sleep 1
    s_add_u32 s96, s96, 1
    s_cmp_lt_u32 s96, 2097152
    s_cbranch_scc1 L_lw_63
L_lwd_64:
    s_branch L_kv_go1
L_kv_last:
    v_mfma_f32_16x16x32_bf16 v[248:251], v[92:95], v[56:59], v[248:251]
    v_mfma_f32_16x16x32_bf16 v[252:255], v[92:95], v[60:63], v[252:255]
    s_waitcnt lgkmcnt(0)
    s_nop 6
    v_mov_b32 v12, 0x3f803f80
    v_mov_b32 v13, v12
    v_mov_b32 v14, v12
    v_mov_b32 v15, v12
    v_and_b32 v9, 3, v2
    v_lshlrev_b32 v9, 8, v9
    v_add_u32 v9, 160000, v9
    v_pk_mul_f32 v[64:65], v[96:97], s[60:61]
    v_pk_mul_f32 v[66:67], v[98:99], s[60:61]
    v_exp_f32 v64, v64 clamp
    v_exp_f32 v65, v65 clamp
    v_exp_f32 v66, v66 clamp
    v_exp_f32 v67, v67 clamp
    v_max_f32 v96, s66, v96
    v_max_f32 v97, s66, v97
    v_max_f32 v98, s66, v98
    v_max_f32 v99, s66, v99
    v_pk_add_f32 v[96:97], v[96:97], v[64:65]
    v_pk_add_f32 v[98:99], v[98:99], v[66:67]
    v_pk_mul_f32 v[68:69], v[100:101], s[60:61]
    v_pk_mul_f32 v[70:71], v[102:103], s[60:61]
    v_exp_f32 v68, v68 clamp
    v_exp_f32 v69, v69 clamp
    v_exp_f32 v70, v70 clamp
    v_exp_f32 v71, v71 clamp
    v_max_f32 v100, s66, v100
    v_max_f32 v101, s66, v101
    v_max_f32 v102, s66, v102
    v_max_f32 v103, s66, v103
    v_pk_add_f32 v[100:101], v[100:101], v[68:69]
    v_pk_add_f32 v[102:103], v[102:103], v[70:71]
    v_pk_mul_f32 v[72:73], v[112:113], s[60:61]
    v_pk_mul_f32 v[74:75], v[114:115], s[60:61]
    v_exp_f32 v72, v72 clamp
    v_exp_f32 v73, v73 clamp
    v_exp_f32 v74, v74 clamp
    v_exp_f32 v75, v75 clamp
    v_max_f32 v80, s66, v112
    v_max_f32 v81, s66, v113
    v_max_f32 v82, s66, v114
    v_max_f32 v83, s66, v115
    v_pk_add_f32 v[80:81], v[80:81], v[72:73]
    v_pk_add_f32 v[82:83], v[82:83], v[74:75]
    v_cndmask_b32 v112, v112, v80, s[68:69]
    v_cndmask_b32 v113, v113, v81, s[68:69]
    v_cndmask_b32 v114, v114, v82, s[68:69]
    v_cndmask_b32 v115, v115, v83, s[68:69]
    v_pk_mul_f32 v[76:77], v[116:117], s[60:61]
    v_pk_mul_f32 v[78:79], v[118:119], s[60:61]
    v_exp_f32 v76, v76 clamp
    v_exp_f32 v77, v77 clamp
    v_exp_f32 v78, v78 clamp
    v_exp_f32 v79, v79 clamp
    v_max_f32 v116, s66, v116
    v_max_f32 v117, s66, v117
    v_max_f32 v118, s66, v118
    v_max_f32 v119, s66, v119
    v_pk_add_f32 v[116:117], v[116:117], v[76:77]
    v_pk_add_f32 v[118:119], v[118:119], v[78:79]
    v_pk_mul_f32 v[64:65], v[120:121], s[60:61]
    v_pk_mul_f32 v[66:67], v[122:123], s[60:61]
    v_exp_f32 v64, v64 clamp
    v_exp_f32 v65, v65 clamp
    v_exp_f32 v66, v66 clamp
    v_exp_f32 v67, v67 clamp
    v_max_f32 v120, s66, v120
    v_max_f32 v121, s66, v121
    v_max_f32 v122, s66, v122
    v_max_f32 v123, s66, v123
    v_pk_add_f32 v[120:121], v[120:121], v[64:65]
    v_pk_add_f32 v[122:123], v[122:123], v[66:67]
    v_pk_mul_f32 v[68:69], v[132:133], s[60:61]
    v_pk_mul_f32 v[70:71], v[134:135], s[60:61]
    v_exp_f32 v68, v68 clamp
    v_exp_f32 v69, v69 clamp
    v_exp_f32 v70, v70 clamp
    v_exp_f32 v71, v71 clamp
    v_max_f32 v84, s66, v132
    v_max_f32 v85, s66, v133
    v_max_f32 v86, s66, v134
    v_max_f32 v87, s66, v135
    v_pk_add_f32 v[84:85], v[84:85], v[68:69]
    v_pk_add_f32 v[86:87], v[86:87], v[70:71]
    v_cndmask_b32 v132, v132, v84, s[68:69]
    v_cndmask_b32 v133, v133, v85, s[68:69]
    v_cndmask_b32 v134, v134, v86, s[68:69]
    v_cndmask_b32 v135, v135, v87, s[68:69]
    v_pk_mul_f32 v[72:73], v[136:137], s[60:61]
    v_pk_mul_f32 v[74:75], v[138:139], s[60:61]
    v_exp_f32 v72, v72 clamp
    v_exp_f32 v73, v73 clamp
    v_exp_f32 v74, v74 clamp
    v_exp_f32 v75, v75 clamp
    v_max_f32 v136, s66, v136
    v_max_f32 v137, s66, v137
    v_max_f32 v138, s66, v138
    v_max_f32 v139, s66, v139
    v_pk_add_f32 v[136:137], v[136:137], v[72:73]
    v_pk_add_f32 v[138:139], v[138:139], v[74:75]
    v_pk_mul_f32 v[76:77], v[140:141], s[60:61]
    v_pk_mul_f32 v[78:79], v[142:143], s[60:61]
    v_exp_f32 v76, v76 clamp
    v_exp_f32 v77, v77 clamp
    v_exp_f32 v78, v78 clamp
    v_exp_f32 v79, v79 clamp
    v_max_f32 v140, s66, v140
    v_max_f32 v141, s66, v141
    v_max_f32 v142, s66, v142
    v_max_f32 v143, s66, v143
    v_pk_add_f32 v[140:141], v[140:141], v[76:77]
    v_pk_add_f32 v[142:143], v[142:143], v[78:79]
    v_pk_mul_f32 v[64:65], v[152:153], s[60:61]
    v_pk_mul_f32 v[66:67], v[154:155], s[60:61]
    v_exp_f32 v64, v64 clamp
    v_exp_f32 v65, v65 clamp
    v_exp_f32 v66, v66 clamp
    v_exp_f32 v67, v67 clamp
    v_max_f32 v80, s66, v152
    v_max_f32 v81, s66, v153
    v_max_f32 v82, s66, v154
    v_max_f32 v83, s66, v155
    v_pk_add_f32 v[80:81], v[80:81], v[64:65]
    v_pk_add_f32 v[82:83], v[82:83], v[66:67]
    v_cndmask_b32 v152, v152, v80, s[68:69]
    v_cndmask_b32 v153, v153, v81, s[68:69]
    v_cndmask_b32 v154, v154, v82, s[68:69]
    v_cndmask_b32 v155, v155, v83, s[68:69]
    v_pk_mul_f32 v[68:69], v[156:157], s[60:61]
    v_pk_mul_f32 v[70:71], v[158:159], s[60:61]
    v_exp_f32 v68, v68 clamp
    v_exp_f32 v69, v69 clamp
    v_exp_f32 v70, v70 clamp
    v_exp_f32 v71, v71 clamp
    v_max_f32 v156, s66, v156
    v_max_f32 v157, s66, v157
    v_max_f32 v158, s66, v158
    v_max_f32 v159, s66, v159
    v_pk_add_f32 v[156:157], v[156:157], v[68:69]
    v_pk_add_f32 v[158:159], v[158:159], v[70:71]
    v_pk_mul_f32 v[72:73], v[160:161], s[60:61]
    v_pk_mul_f32 v[74:75], v[162:163], s[60:61]
    v_exp_f32 v72, v72 clamp
    v_exp_f32 v73, v73 clamp
    v_exp_f32 v74, v74 clamp
    v_exp_f32 v75, v75 clamp
    v_max_f32 v160, s66, v160
    v_max_f32 v161, s66, v161
    v_max_f32 v162, s66, v162
    v_max_f32 v163, s66, v163
    v_pk_add_f32 v[160:161], v[160:161], v[72:73]
    v_pk_add_f32 v[162:163], v[162:163], v[74:75]
    v_pk_mul_f32 v[76:77], v[172:173], s[60:61]
    v_pk_mul_f32 v[78:79], v[174:175], s[60:61]
    v_exp_f32 v76, v76 clamp
    v_exp_f32 v77, v77 clamp
    v_exp_f32 v78, v78 clamp
    v_exp_f32 v79, v79 clamp
    v_max_f32 v84, s66, v172
    v_max_f32 v85, s66, v173
    v_max_f32 v86, s66, v174
    v_max_f32 v87, s66, v175
    v_pk_add_f32 v[84:85], v[84:85], v[76:77]
    v_pk_add_f32 v[86:87], v[86:87], v[78:79]
    v_cndmask_b32 v172, v172, v84, s[68:69]
    v_cndmask_b32 v173, v173, v85, s[68:69]
    v_cndmask_b32 v174, v174, v86, s[68:69]
    v_cndmask_b32 v175, v175, v87, s[68:69]
    v_pk_mul_f32 v[64:65], v[176:177], s[60:61]
    v_pk_mul_f32 v[66:67], v[178:179], s[60:61]
    v_exp_f32 v64, v64 clamp
    v_exp_f32 v65, v65 clamp
    v_exp_f32 v66, v66 clamp
    v_exp_f32 v67, v67 clamp
    v_max_f32 v176, s66, v176
    v_max_f32 v177, s66, v177
    v_max_f32 v178, s66, v178
    v_max_f32 v179, s66, v179
    v_pk_add_f32 v[176:177], v[176:177], v[64:65]
    v_pk_add_f32 v[178:179], v[178:179], v[66:67]
    v_pk_mul_f32 v[68:69], v[180:181], s[60:61]
    v_pk_mul_f32 v[70:71], v[182:183], s[60:61]
    v_exp_f32 v68, v68 clamp
    v_exp_f32 v69, v69 clamp
    v_exp_f32 v70, v70 clamp
    v_exp_f32 v71, v71 clamp
    v_max_f32 v180, s66, v180
    v_max_f32 v181, s66, v181
    v_max_f32 v182, s66, v182
    v_max_f32 v183, s66, v183
    v_pk_add_f32 v[180:181], v[180:181], v[68:69]
    v_pk_add_f32 v[182:183], v[182:183], v[70:71]
    v_pk_mul_f32 v[72:73], v[192:193], s[60:61]
    v_pk_mul_f32 v[74:75], v[194:195], s[60:61]
    v_exp_f32 v72, v72 clamp
    v_exp_f32 v73, v73 clamp
    v_exp_f32 v74, v74 clamp
    v_exp_f32 v75, v75 clamp
    v_max_f32 v80, s66, v192
    v_max_f32 v81, s66, v193
    v_max_f32 v82, s66, v194
    v_max_f32 v83, s66, v195
    v_pk_add_f32 v[80:81], v[80:81], v[72:73]
    v_pk_add_f32 v[82:83], v[82:83], v[74:75]
    v_cndmask_b32 v192, v192, v80, s[68:69]
    v_cndmask_b32 v193, v193, v81, s[68:69]
    v_cndmask_b32 v194, v194, v82, s[68:69]
    v_cndmask_b32 v195, v195, v83, s[68:69]
    v_pk_mul_f32 v[76:77], v[196:197], s[60:61]
    v_pk_mul_f32 v[78:79], v[198:199], s[60:61]
    v_exp_f32 v76, v76 clamp
    v_exp_f32 v77, v77 clamp
    v_exp_f32 v78, v78 clamp
    v_exp_f32 v79, v79 clamp
    v_max_f32 v196, s66, v196
    v_max_f32 v197, s66, v197
    v_max_f32 v198, s66, v198
    v_max_f32 v199, s66, v199
    v_pk_add_f32 v[196:197], v[196:197], v[76:77]
    v_pk_add_f32 v[198:199], v[198:199], v[78:79]
    v_pk_mul_f32 v[64:65], v[200:201], s[60:61]
    v_pk_mul_f32 v[66:67], v[202:203], s[60:61]
    v_exp_f32 v64, v64 clamp
    v_exp_f32 v65, v65 clamp
    v_exp_f32 v66, v66 clamp
    v_exp_f32 v67, v67 clamp
    v_max_f32 v200, s66, v200
    v_max_f32 v201, s66, v201
    v_max_f32 v202, s66, v202
    v_max_f32 v203, s66, v203
    v_pk_add_f32 v[200:201], v[200:201], v[64:65]
    v_pk_add_f32 v[202:203], v[202:203], v[66:67]
    v_pk_mul_f32 v[68:69], v[212:213], s[60:61]
    v_pk_mul_f32 v[70:71], v[214:215], s[60:61]
    v_exp_f32 v68, v68 clamp
    v_exp_f32 v69, v69 clamp
    v_exp_f32 v70, v70 clamp
    v_exp_f32 v71, v71 clamp
    v_max_f32 v84, s66, v212
    v_max_f32 v85, s66, v213
    v_max_f32 v86, s66, v214
    v_max_f32 v87, s66, v215
    v_pk_add_f32 v[84:85], v[84:85], v[68:69]
    v_pk_add_f32 v[86:87], v[86:87], v[70:71]
    v_cndmask_b32 v212, v212, v84, s[68:69]
    v_cndmask_b32 v213, v213, v85, s[68:69]
    v_cndmask_b32 v214, v214, v86, s[68:69]
    v_cndmask_b32 v215, v215, v87, s[68:69]
    v_pk_mul_f32 v[72:73], v[216:217], s[60:61]
    v_pk_mul_f32 v[74:75], v[218:219], s[60:61]
    v_exp_f32 v72, v72 clamp
    v_exp_f32 v73, v73 clamp
    v_exp_f32 v74, v74 clamp
    v_exp_f32 v75, v75 clamp
    v_max_f32 v216, s66, v216
    v_max_f32 v217, s66, v217
    v_max_f32 v218, s66, v218
    v_max_f32 v219, s66, v219
    v_pk_add_f32 v[216:217], v[216:217], v[72:73]
    v_pk_add_f32 v[218:219], v[218:219], v[74:75]
    v_pk_mul_f32 v[76:77], v[220:221], s[60:61]
    v_pk_mul_f32 v[78:79], v[222:223], s[60:61]
    v_exp_f32 v76, v76 clamp
    v_exp_f32 v77, v77 clamp
    v_exp_f32 v78, v78 clamp
    v_exp_f32 v79, v79 clamp
    v_max_f32 v220, s66, v220
    v_max_f32 v221, s66, v221
    v_max_f32 v222, s66, v222
    v_max_f32 v223, s66, v223
    v_pk_add_f32 v[220:221], v[220:221], v[76:77]
    v_pk_add_f32 v[222:223], v[222:223], v[78:79]
    v_pk_mul_f32 v[64:65], v[232:233], s[60:61]
    v_pk_mul_f32 v[66:67], v[234:235], s[60:61]
    v_exp_f32 v64, v64 clamp
    v_exp_f32 v65, v65 clamp
    v_exp_f32 v66, v66 clamp
    v_exp_f32 v67, v67 clamp
    v_max_f32 v80, s66, v232
    v_max_f32 v81, s66, v233
    v_max_f32 v82, s66, v234
    v_max_f32 v83, s66, v235
    v_pk_add_f32 v[80:81], v[80:81], v[64:65]
    v_pk_add_f32 v[82:83], v[82:83], v[66:67]
    v_cndmask_b32 v232, v232, v80, s[68:69]
    v_cndmask_b32 v233, v233, v81, s[68:69]
    v_cndmask_b32 v234, v234, v82, s[68:69]
    v_cndmask_b32 v235, v235, v83, s[68:69]
    s_movk_i32 s54, 84
    buffer_load_dword v0, s[44:47], s54 offen lds
    v_pk_mul_f32 v[68:69], v[236:237], s[60:61]
    v_pk_mul_f32 v[70:71], v[238:239], s[60:61]
    v_exp_f32 v68, v68 clamp
    v_exp_f32 v69, v69 clamp
    v_exp_f32 v70, v70 clamp
    v_exp_f32 v71, v71 clamp
    v_max_f32 v236, s66, v236
    v_max_f32 v237, s66, v237
    v_max_f32 v238, s66, v238
    v_max_f32 v239, s66, v239
    v_pk_add_f32 v[236:237], v[236:237], v[68:69]
    v_pk_add_f32 v[238:239], v[238:239], v[70:71]
    v_pk_mul_f32 v[72:73], v[240:241], s[60:61]
    v_pk_mul_f32 v[74:75], v[242:243], s[60:61]
    v_exp_f32 v72, v72 clamp
    v_exp_f32 v73, v73 clamp
    v_exp_f32 v74, v74 clamp
    v_exp_f32 v75, v75 clamp
    v_max_f32 v240, s66, v240
    v_max_f32 v241, s66, v241
    v_max_f32 v242, s66, v242
    v_max_f32 v243, s66, v243
    v_pk_add_f32 v[240:241], v[240:241], v[72:73]
    v_pk_add_f32 v[242:243], v[242:243], v[74:75]
    v_pk_mul_f32 v[76:77], v[252:253], s[60:61]
    v_pk_mul_f32 v[78:79], v[254:255], s[60:61]
    v_exp_f32 v76, v76 clamp
    v_exp_f32 v77, v77 clamp
    v_exp_f32 v78, v78 clamp
    v_exp_f32 v79, v79 clamp
    v_max_f32 v84, s66, v252
    v_max_f32 v85, s66, v253
    v_max_f32 v86, s66, v254
    v_max_f32 v87, s66, v255
    v_pk_add_f32 v[84:85], v[84:85], v[76:77]
    v_pk_add_f32 v[86:87], v[86:87], v[78:79]
    v_cndmask_b32 v252, v252, v84, s[68:69]
    v_cndmask_b32 v253, v253, v85, s[68:69]
    v_cndmask_b32 v254, v254, v86, s[68:69]
    v_cndmask_b32 v255, v255, v87, s[68:69]
    ds_read_b64 v[4:5], v3 offset:32
    ds_read_b32 v8, v9
    v_cvt_pk_bf16_f32 v96, v96, v97
    v_cvt_pk_bf16_f32 v97, v98, v99
    v_cvt_pk_bf16_f32 v98, v116, v117
    v_cvt_pk_bf16_f32 v99, v118, v119
    v_cvt_pk_bf16_f32 v100, v100, v101
    v_cvt_pk_bf16_f32 v101, v102, v103
    v_cvt_pk_bf16_f32 v102, v120, v121
    v_cvt_pk_bf16_f32 v103, v122, v123
    v_cvt_pk_bf16_f32 v104, v104, v105
    v_cvt_pk_bf16_f32 v105, v106, v107
    v_cvt_pk_bf16_f32 v106, v124, v125
    v_cvt_pk_bf16_f32 v107, v126, v127
    v_cvt_pk_bf16_f32 v108, v108, v109
    v_cvt_pk_bf16_f32 v109, v110, v111
    v_cvt_pk_bf16_f32 v110, v128, v129
    v_cvt_pk_bf16_f32 v111, v130, v131
    v_cvt_pk_bf16_f32 v112, v112, v113
    v_cvt_pk_bf16_f32 v113, v114, v115
    v_cvt_pk_bf16_f32 v114, v132, v133
    v_cvt_pk_bf16_f32 v115, v134, v135
    v_cvt_pk_bf16_f32 v136, v136, v137
    v_cvt_pk_bf16_f32 v137, v138, v139
    v_mfma_f32_16x16x32_bf16 v[24:27], v[104:107], v[96:99], 0
    v_cvt_pk_bf16_f32 v138, v156, v157
    v_cvt_pk_bf16_f32 v139, v158, v159
    v_mfma_f32_16x16x32_bf16 v[28:31], v[108:111], v[100:103], 0
    v_cvt_pk_bf16_f32 v140, v140, v141
    v_cvt_pk_bf16_f32 v141, v142, v143
    v_mfma_f32_16x16x32_bf16 v[32:35], v[112:115], v[96:99], 0
    v_cvt_pk_bf16_f32 v142, v160, v161
    v_cvt_pk_bf16_f32 v143, v162, v163
    v_mfma_f32_16x16x32_bf16 v[36:39], v[112:115], v[100:103], 0
    v_cvt_pk_bf16_f32 v144, v144, v145
    v_cvt_pk_bf16_f32 v145, v146, v147
    v_mfma_f32_16x16x32_bf16 v[40:43], v[104:107], v[112:115], 0
    v_cvt_pk_bf16_f32 v146, v164, v165
    v_cvt_pk_bf16_f32 v147, v166, v167
    v_mfma_f32_16x16x32_bf16 v[44:47], v[108:111], v[112:115], 0
    v_cvt_pk_bf16_f32 v148, v148, v149
    v_cvt_pk_bf16_f32 v149, v150, v151
    v_mfma_f32_16x16x32_bf16 v[48:51], v[112:115], v[112:115], 0
    v_cvt_pk_bf16_f32 v150, v168, v169
    v_cvt_pk_bf16_f32 v151, v170, v171
    v_mfma_f32_16x16x32_bf16 v[52:55], v[96:99], v[12:15], 0
    v_cvt_pk_bf16_f32 v152, v152, v153
    v_cvt_pk_bf16_f32 v153, v154, v155
    v_mfma_f32_16x16x32_bf16 v[56:59], v[100:103], v[12:15], 0
    v_cvt_pk_bf16_f32 v154, v172, v173
    v_cvt_pk_bf16_f32 v155, v174, v175
    v_mfma_f32_16x16x32_bf16 v[60:63], v[112:115], v[12:15], 0
    v_cvt_pk_bf16_f32 v176, v176, v177
    v_cvt_pk_bf16_f32 v177, v178, v179
    v_mfma_f32_16x16x32_bf16 v[24:27], v[144:147], v[136:139], v[24:27]
    v_cvt_pk_bf16_f32 v178, v196, v197
    v_cvt_pk_bf16_f32 v179, v198, v199
    v_mfma_f32_16x16x32_bf16 v[28:31], v[148:151], v[140:143], v[28:31]
    v_cvt_pk_bf16_f32 v180, v180, v181
    v_cvt_pk_bf16_f32 v181, v182, v183
    v_mfma_f32_16x16x32_bf16 v[32:35], v[152:155], v[136:139], v[32:35]
    v_cvt_pk_bf16_f32 v182, v200, v201
    v_cvt_pk_bf16_f32 v183, v202, v203
    v_mfma_f32_16x16x32_bf16 v[36:39], v[152:155], v[140:143], v[36:39]
    v_cvt_pk_bf16_f32 v184, v184, v185
    v_cvt_pk_bf16_f32 v185, v186, v187
    v_mfma_f32_16x16x32_bf16 v[40:43], v[144:147], v[152:155], v[40:43]
    v_cvt_pk_bf16_f32 v186, v204, v205
    v_cvt_pk_bf16_f32 v187, v206, v207
    v_mfma_f32_16x16x32_bf16 v[44:47], v[148:151], v[152:155], v[44:47]
    v_cvt_pk_bf16_f32 v188, v188, v189
    v_cvt_pk_bf16_f32 v189, v190, v191
    v_mfma_f32_16x16x32_bf16 v[48:51], v[152:155], v[152:155], v[48:51]
    v_cvt_pk_bf16_f32 v190, v208, v209
    v_cvt_pk_bf16_f32 v191, v210, v211
    v_mfma_f32_16x16x32_bf16 v[52:55], v[136:139], v[12:15], v[52:55]
    v_cvt_pk_bf16_f32 v192, v192, v193
    v_cvt_pk_bf16_f32 v193, v194, v195
    v_mfma_f32_16x16x32_bf16 v[56:59], v[140:143], v[12:15], v[56:59]
    v_cvt_pk_bf16_f32 v194, v212, v213
    v_cvt_pk_bf16_f32 v195, v214, v215
    v_mfma_f32_16x16x32_bf16 v[60:63], v[152:155], v[12:15], v[60:63]
    v_cvt_pk_bf16_f32 v216, v216, v217
    v_cvt_pk_bf16_f32 v217, v218, v219
    v_mfma_f32_16x16x32_bf16 v[24:27], v[184:187], v[176:179], v[24:27]
    v_cvt_pk_bf16_f32 v218, v236, v237
    v_cvt_pk_bf16_f32 v219, v238, v239
    v_mfma_f32_16x16x32_bf16 v[28:31], v[188:191], v[180:183], v[28:31]
    v_cvt_pk_bf16_f32 v220, v220, v221
    v_cvt_pk_bf16_f32 v221, v222, v223
    v_mfma_f32_16x16x32_bf16 v[32:35], v[192:195], v[176:179], v[32:35]
    v_cvt_pk_bf16_f32 v222, v240, v241
    v_cvt_pk_bf16_f32 v223, v242, v243
    v_mfma_f32_16x16x32_bf16 v[36:39], v[192:195], v[180:183], v[36:39]
    v_cvt_pk_bf16_f32 v224, v224, v225
    v_cvt_pk_bf16_f32 v225, v226, v227
    v_mfma_f32_16x16x32_bf16 v[40:43], v[184:187], v[192:195], v[40:43]
    v_cvt_pk_bf16_f32 v226, v244, v245
    v_cvt_pk_bf16_f32 v227, v246, v247
    v_mfma_f32_16x16x32_bf16 v[44:47], v[188:191], v[192:195], v[44:47]
    v_cvt_pk_bf16_f32 v228, v228, v229
    v_cvt_pk_bf16_f32 v229, v230, v231
    v_mfma_f32_16x16x32_bf16 v[48:51], v[192:195], v[192:195], v[48:51]
    v_cvt_pk_bf16_f32 v230, v248, v249
    v_cvt_pk_bf16_f32 v231, v250, v251
    v_mfma_f32_16x16x32_bf16 v[52:55], v[176:179], v[12:15], v[52:55]
    v_cvt_pk_bf16_f32 v232, v232, v233
    v_cvt_pk_bf16_f32 v233, v234, v235
    v_mfma_f32_16x16x32_bf16 v[56:59], v[180:183], v[12:15], v[56:59]
    v_cvt_pk_bf16_f32 v234, v252, v253
    v_cvt_pk_bf16_f32 v235, v254, v255
    v_mfma_f32_16x16x32_bf16 v[60:63], v[192:195], v[12:15], v[60:63]
    s_waitcnt lgkmcnt(0)
    v_cmp_gt_u32 vcc, 18, v8
    v_mfma_f32_16x16x32_bf16 v[24:27], v[224:227], v[216:219], v[24:27]
    v_readfirstlane_b32 s88, v4
    v_mfma_f32_16x16x32_bf16 v[28:31], v[228:231], v[220:223], v[28:31]
    v_readfirstlane_b32 s89, v5
    v_mfma_f32_16x16x32_bf16 v[32:35], v[232:235], v[216:219], v[32:35]
    s_cmp_eq_u32 s88, 0
    v_mfma_f32_16x16x32_bf16 v[36:39], v[232:235], v[220:223], v[36:39]
    s_cselect_b32 vcc_lo, 1, vcc_lo
    v_mfma_f32_16x16x32_bf16 v[40:43], v[224:227], v[232:235], v[40:43]
    s_cmp_eq_u64 vcc, 0
    v_mfma_f32_16x16x32_bf16 v[44:47], v[228:231], v[232:235], v[44:47]
    v_mfma_f32_16x16x32_bf16 v[48:51], v[232:235], v[232:235], v[48:51]
    v_mfma_f32_16x16x32_bf16 v[52:55], v[216:219], v[12:15], v[52:55]
    v_mfma_f32_16x16x32_bf16 v[56:59], v[220:223], v[12:15], v[56:59]
    v_mfma_f32_16x16x32_bf16 v[60:63], v[232:235], v[12:15], v[60:63]
    s_cbranch_scc1 L_kv_chkok
    s_mov_b32 s96, 0
L_ep_65:
    ds_read_b64 v[6:7], v3 offset:32
    s_waitcnt lgkmcnt(0)
    v_readfirstlane_b32 s88, v6
    v_readfirstlane_b32 s89, v7
    s_add_u32 s96, s96, 1
    s_cmp_eq_u32 s88, 0
    s_cselect_b32 s48, s96, -1
    s_cmp_lt_u32 s48, 2097152
    s_cbranch_scc1 L_ep_65
    s_mov_b32 s96, 0
L_lw_66:
    ds_read_b32 v8, v9
    s_waitcnt lgkmcnt(0)
    v_readlane_b32 s90, v8, 0
    v_readlane_b32 s48, v8, 1
    s_min_u32 s90, s90, s48
    v_readlane_b32 s48, v8, 2
    s_min_u32 s90, s90, s48
    v_readlane_b32 s48, v8, 3
    s_min_u32 s90, s90, s48
    s_cmp_ge_i32 s90, 18
    s_cbranch_scc1 L_lwd_67
    s_sleep 1
    s_add_u32 s96, s96, 1
    s_cmp_lt_u32 s96, 2097152
    s_cbranch_scc1 L_lw_66
L_lwd_67:
L_kv_chkok:
    ds_write_b128 v23, v[24:27] offset:0
    ds_write_b128 v23, v[28:31] offset:1792
    s_mov_b32 exec_lo, 0x0
    s_mov_b32 exec_hi, 0xffff
    ds_write_b128 v23, v[32:35] offset:32
    s_mov_b32 exec_lo, 0x0
    s_mov_b32 exec_hi, 0xffff0000
    ds_write_b128 v23, v[36:39] offset:1808
    s_mov_b32 exec_lo, 0xf000f
    s_mov_b32 exec_hi, 0xf000f
    ds_write_b128 v23, v[40:43] offset:1280
    s_mov_b32 exec_lo, 0xf000f0
    s_mov_b32 exec_hi, 0xf000f0
    ds_write_b128 v23, v[44:47] offset:2752
    s_mov_b32 exec_lo, 0x0
    s_mov_b32 exec_hi, 0xf
    ds_write_b128 v23, v[48:51] offset:1312
    s_mov_b32 exec_lo, 0x0
    s_mov_b32 exec_hi, 0xf00000
    ds_write_b128 v23, v[48:51] offset:2768
    s_mov_b32 exec_lo, 0x10001
    s_mov_b32 exec_hi, 0x10001
    ds_write_b128 v23, v[52:55] offset:1600
    s_mov_b32 exec_lo, 0x10001
    s_mov_b32 exec_hi, 0x10001
    ds_write_b128 v23, v[56:59] offset:3392
    s_mov_b32 exec_lo, 0x1
    s_mov_b32 exec_hi, 0x0
    ds_write_b128 v23, v[60:63] offset:1664
    s_mov_b32 exec_lo, 0x10000
    s_mov_b32 exec_hi, 0x0
    ds_write_b128 v23, v[60:63] offset:3440
    s_mov_b64 exec, -1
    v_add_u32 v9, s71, v22
    ds_read_b128 v[64:67], v9 offset:0
    ds_read_b128 v[68:71], v9 offset:1024
    ds_read_b128 v[72:75], v9 offset:2048
    ds_read_b128 v[76:79], v9 offset:3072
    s_and_b32 s76, s88, 0xfff
    s_bfe_u32 s77, s88, 0xc000c
    s_lshr_b64 s[78:79], s[88:89], 24
    s_xor_b32 s78, s78, s88
    s_bfe_u32 s79, s78, 0xc000c
    s_and_b32 s78, s78, 0xfff
    v_mov_b32 v6, 0xfffff000
    s_waitcnt lgkmcnt(3)
    v_and_or_b32 v64, v64, v6, s76
    v_and_or_b32 v65, v65, v6, s77
    v_and_or_b32 v66, v66, v6, s78
    v_and_or_b32 v67, v67, v6, s79
    buffer_store_dwordx4 v[64:67], v22, s[40:43], s70 offen offset:0 sc1
    s_waitcnt lgkmcnt(2)
    v_and_or_b32 v68, v68, v6, s76
    v_and_or_b32 v69, v69, v6, s77
    v_and_or_b32 v70, v70, v6, s78
    v_and_or_b32 v71, v71, v6, s79
    buffer_store_dwordx4 v[68:71], v22, s[40:43], s70 offen offset:1024 sc1
    s_waitcnt lgkmcnt(1)
    v_and_or_b32 v72, v72, v6, s76
    v_and_or_b32 v73, v73, v6, s77
    v_and_or_b32 v74, v74, v6, s78
    v_and_or_b32 v75, v75, v6, s79
    buffer_store_dwordx4 v[72:75], v22, s[40:43], s70 offen offset:2048 sc1
    s_waitcnt lgkmcnt(0)
    v_and_or_b32 v76, v76, v6, s76
    v_and_or_b32 v77, v77, v6, s77
    v_and_or_b32 v78, v78, v6, s78
    v_and_or_b32 v79, v79, v6, s79
    s_mov_b32 exec_hi, 0
    buffer_store_dwordx4 v[76:79], v22, s[40:43], s70 offen offset:3072 sc1
    s_mov_b64 exec, -1
    s_movk_i32 s54, 88
    buffer_load_dword v0, s[44:47], s54 offen lds
L_p1_done:
    s_load_dwordx2 s[8:9], s[0:1], 64
    v_mov_b32 v0, 159744
    v_lshrrev_b32 v3, 4, v2
    v_and_b32 v4, 15, v2
    v_lshlrev_b32 v5, 4, v2
    v_lshlrev_b32 v6, 3, v2
    v_add_u32 v7, 4096, v5
    s_cmp_lg_u32 s20, 0
    s_cbranch_scc1 L_a_g
    s_and_b32 s69, s2, 7
    s_lshl_b32 s69, s69, 3
    s_bfe_u32 s48, s2, 0x30003
    s_add_u32 s69, s69, s48
    s_lshr_b32 s18, s69, 2
    s_lshl_b32 s18, s18, 1
    s_and_b32 s48, s21, 1
    s_add_u32 s18, s18, s48
    s_and_b32 s19, s69, 3
    s_lshl_b32 s19, s19, 1
    s_lshr_b32 s48, s21, 1
    s_add_u32 s19, s19, s48
    v_lshrrev_b32 v3, 4, v2
    v_and_b32 v4, 15, v2
    s_mul_i32 s70, s21, 5120
    s_lshr_b32 s50, s18, 1
    s_and_b32 s51, s18, 1
    s_mul_i32 s48, s51, 1792
    v_add_u32 v10, s48, v5
    v_add_u32 v11, 1024, v10
    v_mov_b32 v15, 2147418112
    v_cmp_lt_u32 vcc, 40, v2
    s_nop 1
    v_cndmask_b32 v11, v11, v15, vcc
    v_mov_b32 v19, v5
    v_add_u32 v20, 1024, v5
    v_mul_u32_u24 v21, 80, v4
    v_lshl_add_u32 v12, v3, 5, v21
    v_lshlrev_b32 v13, 3, v4
    v_bfe_u32 v14, v2, 2, 2
    v_lshl_add_u32 v14, v3, 3, v14
    v_mul_u32_u24 v14, 160, v14
    v_and_b32 v15, 3, v2
    v_lshl_add_u32 v14, v15, 3, v14
    v_add_u32 v14, s70, v14
    v_add_u32 v19, s70, v19
    v_add_u32 v20, s70, v20
    s_mul_i32 s48, s51, 5120
    v_add_u32 v12, s48, v12
    v_add_u32 v13, s48, v13
    v_cmp_gt_u32 s[60:61], 3, v3
    v_cmp_gt_u32 s[62:63], 2, v3
    v_cmp_gt_u32 s[64:65], 41, v2
    s_mul_i32 s48, s51, 5
    s_lshr_b32 s49, s21, 1
    s_mul_i32 s49, s49, 110592
    s_add_u32 s49, s49, 40960
    v_add3_u32 v15, v3, s48, 0
    v_lshrrev_b32 v16, 1, v15
    v_mul_u32_u24 v16, 1280, v16
    v_and_b32 v15, 1, v15
    v_lshl_add_u32 v16, v15, 3, v16
    v_lshl_add_u32 v16, v4, 4, v16
    v_add_u32 v17, s49, v16
    v_add3_u32 v15, v3, s48, 4
    v_lshrrev_b32 v16, 1, v15
    v_mul_u32_u24 v16, 1280, v16
    v_and_b32 v15, 1, v15
    v_lshl_add_u32 v16, v15, 3, v16
    v_lshl_add_u32 v16, v4, 4, v16
    v_add_u32 v18, s49, v16
    s_mul_i32 s48, s51, 40
    s_add_u32 s48, s48, s49
    s_add_u32 s48, s48, 6400
    v_lshlrev_b32 v22, 2, v2
    v_add_u32 v22, s48, v22
    s_mul_i32 s48, s51, 3328
    s_add_u32 s48, s48, s49
    v_add_u32 v21, s48, v5
    v_lshlrev_b32 v15, 10, v3
    v_lshl_add_u32 v15, v4, 4, v15
    s_lshr_b32 s48, s18, 3
    s_mul_i32 s48, s48, 5
    s_mul_i32 s49, s19, 20
    s_add_u32 s48, s48, s49
    s_mul_i32 s48, s48, 5120
    s_and_b32 s49, s50, 3
    s_lshl_b32 s49, s49, 8
    s_add_u32 s48, s48, s49
    s_mul_i32 s49, s51, 13312
    s_add_u32 s48, s48, s49
    s_add_u32 s55, s48, 11534336
    s_add_u32 s56, s55, 4096
    s_add_u32 s57, s55, 8192
    s_add_u32 s48, s55, 12288
    s_lshl_b32 s54, s19, 11
    s_lshl_b32 s49, s50, 7
    s_add_u32 s54, s54, s49
    s_add_u32 s54, s54, 15794176
    s_cmp_eq_u32 s51, 0
    s_cselect_b32 s54, s48, s54
    s_movk_i32 s48, 255
    s_cselect_b32 s58, 0xffff, s48
    s_mov_b32 s59, 0
    s_and_b32 s76, s88, 0xfff
    s_bfe_u32 s77, s88, 0xc000c
    s_lshr_b64 s[78:79], s[88:89], 24
    s_xor_b32 s78, s78, s88
    s_bfe_u32 s79, s78, 0xc000c
    s_and_b32 s78, s78, 0xfff
    s_mul_i32 s52, s50, 57344
    s_lshr_b32 s49, s21, 1
    s_mul_i32 s49, s49, 28672
    s_add_u32 s52, s52, s49
    s_add_u32 s52, s52, 12582912
    v_and_b32 v8, 7, v2
    v_lshl_add_u32 v8, v8, 1, 0
    v_lshlrev_b32 v9, 4, v8
    v_add_u32 v13, 1600, v9
    v_add_u32 v9, 6640, v9
    v_cmp_lt_u32 vcc, 4, v8
    s_nop 1
    v_cndmask_b32 v13, v13, v9, vcc
    v_and_b32 v8, 7, v2
    v_lshl_add_u32 v8, v8, 1, 1
    v_lshlrev_b32 v9, 4, v8
    v_add_u32 v22, 1600, v9
    v_add_u32 v9, 6640, v9
    v_cmp_lt_u32 vcc, 4, v8
    s_nop 1
    v_cndmask_b32 v22, v22, v9, vcc
    s_lshl_b32 s48, s21, 2
    v_add_u32 v23, s48, v0
    v_mov_b32 v244, 1
    v_mov_b32 v245, 2
    v_mov_b32 v246, 3
    s_mov_b64 exec, 1
    ds_write_b32 v23, v244 offset:192
    s_mov_b64 exec, -1
    s_mov_b32 s96, 0
L_lw_68:
    ds_read_b32 v248, v23 offset:112
    s_waitcnt lgkmcnt(0)
    v_readfirstlane_b32 s90, v248
    s_cmp_ge_i32 s90, 1
    s_cbranch_scc1 L_lwd_69
    s_sleep 1
    s_add_u32 s96, s96, 1
    s_cmp_lt_u32 s96, 2097152
    s_cbranch_scc1 L_lw_68
L_lwd_69:
    ds_read_b64_tr_b16 v[224:225], v14 offset:0
    ds_read_b64_tr_b16 v[226:227], v14 offset:640
    ds_read_b64_tr_b16 v[228:229], v14 offset:32
    ds_read_b64_tr_b16 v[230:231], v14 offset:672
    ds_read_b64_tr_b16 v[232:233], v14 offset:64
    ds_read_b64_tr_b16 v[234:235], v14 offset:704
    ds_read_b64_tr_b16 v[236:237], v14 offset:96
    ds_read_b64_tr_b16 v[238:239], v14 offset:736
    ds_read_b64_tr_b16 v[240:241], v14 offset:128
    ds_read_b64_tr_b16 v[242:243], v14 offset:768
    s_mov_b32 s96, 0
L_lw_70:
    ds_read_b32 v248, v0 offset:72
    s_waitcnt lgkmcnt(0)
    v_readfirstlane_b32 s90, v248
    s_cmp_ge_i32 s90, 1
    s_cbranch_scc1 L_lwd_71
    s_sleep 2
    s_add_u32 s96, s96, 1
    s_cmp_lt_u32 s96, 2097152
    s_cbranch_scc1 L_lw_70
L_lwd_71:
    s_waitcnt vmcnt(0)
    s_mov_b32 s96, 0
L_pa_gather:
    s_lshl_b32 s53, s69, 1
    s_add_u32 s53, s53, 0
    s_and_b32 s53, s53, 7
    s_mul_i32 s53, s53, 3584
    s_add_u32 s53, s53, s52
    buffer_load_dwordx4 v[24:27], v10, s[40:43], s53 offen sc1
    buffer_load_dwordx4 v[28:31], v11, s[40:43], s53 offen sc1
    s_lshl_b32 s53, s69, 1
    s_add_u32 s53, s53, 1
    s_and_b32 s53, s53, 7
    s_mul_i32 s53, s53, 3584
    s_add_u32 s53, s53, s52
    buffer_load_dwordx4 v[32:35], v10, s[40:43], s53 offen sc1
    buffer_load_dwordx4 v[36:39], v11, s[40:43], s53 offen sc1
    s_lshl_b32 s53, s69, 1
    s_add_u32 s53, s53, 2
    s_and_b32 s53, s53, 7
    s_mul_i32 s53, s53, 3584
    s_add_u32 s53, s53, s52
    buffer_load_dwordx4 v[40:43], v10, s[40:43], s53 offen sc1
    buffer_load_dwordx4 v[44:47], v11, s[40:43], s53 offen sc1
    s_lshl_b32 s53, s69, 1
    s_add_u32 s53, s53, 3
    s_and_b32 s53, s53, 7
    s_mul_i32 s53, s53, 3584
    s_add_u32 s53, s53, s52
    buffer_load_dwordx4 v[48:51], v10, s[40:43], s53 offen sc1
    buffer_load_dwordx4 v[52:55], v11, s[40:43], s53 offen sc1
    s_lshl_b32 s53, s69, 1
    s_add_u32 s53, s53, 4
    s_and_b32 s53, s53, 7
    s_mul_i32 s53, s53, 3584
    s_add_u32 s53, s53, s52
    buffer_load_dwordx4 v[56:59], v10, s[40:43], s53 offen sc1
    buffer_load_dwordx4 v[60:63], v11, s[40:43], s53 offen sc1
    s_lshl_b32 s53, s69, 1
    s_add_u32 s53, s53, 5
    s_and_b32 s53, s53, 7
    s_mul_i32 s53, s53, 3584
    s_add_u32 s53, s53, s52
    buffer_load_dwordx4 v[64:67], v10, s[40:43], s53 offen sc1
    buffer_load_dwordx4 v[68:71], v11, s[40:43], s53 offen sc1
    s_lshl_b32 s53, s69, 1
    s_add_u32 s53, s53, 6
    s_and_b32 s53, s53, 7
    s_mul_i32 s53, s53, 3584
    s_add_u32 s53, s53, s52
    buffer_load_dwordx4 v[72:75], v10, s[40:43], s53 offen sc1
    buffer_load_dwordx4 v[76:79], v11, s[40:43], s53 offen sc1
    s_lshl_b32 s53, s69, 1
    s_add_u32 s53, s53, 7
    s_and_b32 s53, s53, 7
    s_mul_i32 s53, s53, 3584
    s_add_u32 s53, s53, s52
    buffer_load_dwordx4 v[80:83], v10, s[40:43], s53 offen sc1
    buffer_load_dwordx4 v[84:87], v11, s[40:43], s53 offen sc1
    s_waitcnt vmcnt(14)
    v_xor_b32 v24, s76, v24
    v_xor_b32 v25, s77, v25
    v_xor_b32 v26, s78, v26
    v_xor_b32 v27, s79, v27
    v_xor_b32 v28, s76, v28
    v_xor_b32 v29, s77, v29
    v_xor_b32 v30, s78, v30
    v_xor_b32 v31, s79, v31
    v_or3_b32 v8, v24, v25, v26
    v_or_b32 v8, v8, v27
    v_or3_b32 v9, v28, v29, v30
    v_or_b32 v9, v9, v31
    s_waitcnt vmcnt(12)
    v_xor_b32 v32, s76, v32
    v_xor_b32 v33, s77, v33
    v_xor_b32 v34, s78, v34
    v_xor_b32 v35, s79, v35
    v_xor_b32 v36, s76, v36
    v_xor_b32 v37, s77, v37
    v_xor_b32 v38, s78, v38
    v_xor_b32 v39, s79, v39
    v_or3_b32 v8, v8, v32, v33
    v_or3_b32 v8, v8, v34, v35
    v_or3_b32 v9, v9, v36, v37
    v_or3_b32 v9, v9, v38, v39
    v_pk_add_f32 v[24:25], v[24:25], v[32:33]
    v_pk_add_f32 v[26:27], v[26:27], v[34:35]
    v_pk_add_f32 v[28:29], v[28:29], v[36:37]
    v_pk_add_f32 v[30:31], v[30:31], v[38:39]
    s_waitcnt vmcnt(10)
    v_xor_b32 v40, s76, v40
    v_xor_b32 v41, s77, v41
    v_xor_b32 v42, s78, v42
    v_xor_b32 v43, s79, v43
    v_xor_b32 v44, s76, v44
    v_xor_b32 v45, s77, v45
    v_xor_b32 v46, s78, v46
    v_xor_b32 v47, s79, v47
    v_or3_b32 v8, v8, v40, v41
    v_or3_b32 v8, v8, v42, v43
    v_or3_b32 v9, v9, v44, v45
    v_or3_b32 v9, v9, v46, v47
    v_pk_add_f32 v[24:25], v[24:25], v[40:41]
    v_pk_add_f32 v[26:27], v[26:27], v[42:43]
    v_pk_add_f32 v[28:29], v[28:29], v[44:45]
    v_pk_add_f32 v[30:31], v[30:31], v[46:47]
    s_waitcnt vmcnt(8)
    v_xor_b32 v48, s76, v48
    v_xor_b32 v49, s77, v49
    v_xor_b32 v50, s78, v50
    v_xor_b32 v51, s79, v51
    v_xor_b32 v52, s76, v52
    v_xor_b32 v53, s77, v53
    v_xor_b32 v54, s78, v54
    v_xor_b32 v55, s79, v55
    v_or3_b32 v8, v8, v48, v49
    v_or3_b32 v8, v8, v50, v51
    v_or3_b32 v9, v9, v52, v53
    v_or3_b32 v9, v9, v54, v55
    v_pk_add_f32 v[24:25], v[24:25], v[48:49]
    v_pk_add_f32 v[26:27], v[26:27], v[50:51]
    v_pk_add_f32 v[28:29], v[28:29], v[52:53]
    v_pk_add_f32 v[30:31], v[30:31], v[54:55]
    s_waitcnt vmcnt(6)
    v_xor_b32 v56, s76, v56
    v_xor_b32 v57, s77, v57
    v_xor_b32 v58, s78, v58
    v_xor_b32 v59, s79, v59
    v_xor_b32 v60, s76, v60
    v_xor_b32 v61, s77, v61
    v_xor_b32 v62, s78, v62
    v_xor_b32 v63, s79, v63
    v_or3_b32 v8, v8, v56, v57
    v_or3_b32 v8, v8, v58, v59
    v_or3_b32 v9, v9, v60, v61
    v_or3_b32 v9, v9, v62, v63
    v_pk_add_f32 v[24:25], v[24:25], v[56:57]
    v_pk_add_f32 v[26:27], v[26:27], v[58:59]
    v_pk_add_f32 v[28:29], v[28:29], v[60:61]
    v_pk_add_f32 v[30:31], v[30:31], v[62:63]
    s_waitcnt vmcnt(4)
    v_xor_b32 v64, s76, v64
    v_xor_b32 v65, s77, v65
    v_xor_b32 v66, s78, v66
    v_xor_b32 v67, s79, v67
    v_xor_b32 v68, s76, v68
    v_xor_b32 v69, s77, v69
    v_xor_b32 v70, s78, v70
    v_xor_b32 v71, s79, v71
    v_or3_b32 v8, v8, v64, v65
    v_or3_b32 v8, v8, v66, v67
    v_or3_b32 v9, v9, v68, v69
    v_or3_b32 v9, v9, v70, v71
    v_pk_add_f32 v[24:25], v[24:25], v[64:65]
    v_pk_add_f32 v[26:27], v[26:27], v[66:67]
    v_pk_add_f32 v[28:29], v[28:29], v[68:69]
    v_pk_add_f32 v[30:31], v[30:31], v[70:71]
    s_waitcnt vmcnt(2)
    v_xor_b32 v72, s76, v72
    v_xor_b32 v73, s77, v73
    v_xor_b32 v74, s78, v74
    v_xor_b32 v75, s79, v75
    v_xor_b32 v76, s76, v76
    v_xor_b32 v77, s77, v77
    v_xor_b32 v78, s78, v78
    v_xor_b32 v79, s79, v79
    v_or3_b32 v8, v8, v72, v73
    v_or3_b32 v8, v8, v74, v75
    v_or3_b32 v9, v9, v76, v77
    v_or3_b32 v9, v9, v78, v79
    v_pk_add_f32 v[24:25], v[24:25], v[72:73]
    v_pk_add_f32 v[26:27], v[26:27], v[74:75]
    v_pk_add_f32 v[28:29], v[28:29], v[76:77]
    v_pk_add_f32 v[30:31], v[30:31], v[78:79]
    s_waitcnt vmcnt(0)
    v_xor_b32 v80, s76, v80
    v_xor_b32 v81, s77, v81
    v_xor_b32 v82, s78, v82
    v_xor_b32 v83, s79, v83
    v_xor_b32 v84, s76, v84
    v_xor_b32 v85, s77, v85
    v_xor_b32 v86, s78, v86
    v_xor_b32 v87, s79, v87
    v_or3_b32 v8, v8, v80, v81
    v_or3_b32 v8, v8, v82, v83
    v_or3_b32 v9, v9, v84, v85
    v_or3_b32 v9, v9, v86, v87
    v_pk_add_f32 v[24:25], v[24:25], v[80:81]
    v_pk_add_f32 v[26:27], v[26:27], v[82:83]
    v_pk_add_f32 v[28:29], v[28:29], v[84:85]
    v_pk_add_f32 v[30:31], v[30:31], v[86:87]
    v_cndmask_b32 v9, 0, v9, s[64:65]
    v_or_b32 v8, v8, v9
    v_and_b32 v8, 0xfff, v8
    v_cmp_ne_u32 vcc, 0, v8
    s_cbranch_vccz L_pa_got
    s_sleep 8
    s_add_u32 s96, s96, 1
    s_cmp_lt_u32 s96, 131072
    s_cbranch_scc1 L_pa_gather
L_pa_got:
    ds_write_b128 v19, v[24:27]
    ds_write_b128 v20, v[28:31]
    s_mov_b64 exec, 1
    ds_write_b32 v23, v244 offset:80
    s_mov_b64 exec, -1
    s_mov_b32 s96, 0
L_lw_72:
    ds_read_b128 v[248:251], v0 offset:80
    s_waitcnt lgkmcnt(0)
    v_min3_u32 v248, v248, v249, v250
    v_min_u32 v248, v248, v251
    s_nop 0
    v_readfirstlane_b32 s90, v248
    s_cmp_ge_i32 s90, 1
    s_cbranch_scc1 L_lwd_73
    s_sleep 0
    s_add_u32 s96, s96, 1
    s_cmp_lt_u32 s96, 2097152
    s_cbranch_scc1 L_lw_72
L_lwd_73:
    s_cmp_eq_u32 s51, 0
    s_cbranch_scc1 L_pa_noz
    ds_read_b128 v[64:67], v13
    ds_read_b128 v[68:71], v22
    ds_read_b128 v[72:75], v13 offset:10240
    ds_read_b128 v[76:79], v22 offset:10240
    s_waitcnt lgkmcnt(0)
    v_pk_add_f32 v[64:65], v[64:65], v[72:73]
    v_pk_add_f32 v[66:67], v[66:67], v[74:75]
    v_pk_add_f32 v[68:69], v[68:69], v[76:77]
    v_pk_add_f32 v[70:71], v[70:71], v[78:79]
    v_cvt_pk_bf16_f32 v80, v64, v65
    v_cvt_pk_bf16_f32 v81, v66, v67
    v_cvt_pk_bf16_f32 v82, v68, v69
    v_cvt_pk_bf16_f32 v83, v70, v71
    s_mov_b64 exec, 0xff
    buffer_store_dwordx4 v[80:83], v15, s[40:43], s54 offen sc1
    s_mov_b64 exec, -1
L_pa_noz:
    ds_read_b128 v[24:27], v12 offset:0
    ds_read_b128 v[28:31], v12 offset:16
    ds_read_b128 v[32:35], v12 offset:1280
    ds_read_b128 v[36:39], v12 offset:1296
    ds_read_b128 v[44:47], v12 offset:10240
    ds_read_b128 v[48:51], v12 offset:10256
    ds_read_b128 v[52:55], v12 offset:11520
    ds_read_b128 v[56:59], v12 offset:11536
    s_waitcnt lgkmcnt(0)
    v_pk_add_f32 v[24:25], v[24:25], v[44:45]
    v_pk_add_f32 v[26:27], v[26:27], v[46:47]
    v_pk_add_f32 v[28:29], v[28:29], v[48:49]
    v_pk_add_f32 v[30:31], v[30:31], v[50:51]
    v_pk_add_f32 v[32:33], v[32:33], v[52:53]
    v_pk_add_f32 v[34:35], v[34:35], v[54:55]
    v_pk_add_f32 v[36:37], v[36:37], v[56:57]
    v_pk_add_f32 v[38:39], v[38:39], v[58:59]
    v_pk_add_f32 v[40:41], v[40:41], v[60:61]
    v_cvt_pk_bf16_f32 v24, v24, v25
    v_cvt_pk_bf16_f32 v25, v26, v27
    v_cvt_pk_bf16_f32 v26, v28, v29
    v_cvt_pk_bf16_f32 v27, v30, v31
    v_cndmask_b32 v24, 0, v24, s[60:61]
    v_cndmask_b32 v25, 0, v25, s[60:61]
    v_cndmask_b32 v26, 0, v26, s[62:63]
    v_cndmask_b32 v27, 0, v27, s[62:63]
    v_cvt_pk_bf16_f32 v32, v32, v33
    v_cvt_pk_bf16_f32 v33, v34, v35
    v_cvt_pk_bf16_f32 v34, v36, v37
    v_cvt_pk_bf16_f32 v35, v38, v39
    v_cndmask_b32 v32, 0, v32, s[60:61]
    v_cndmask_b32 v33, 0, v33, s[60:61]
    v_cndmask_b32 v34, 0, v34, s[62:63]
    v_cndmask_b32 v35, 0, v35, s[62:63]
    v_cvt_pk_bf16_f32 v40, v40, v41
    s_nop 0
    v_mfma_f32_16x16x32_bf16 v[64:67], v[24:27], v[224:227], 0
    v_mfma_f32_16x16x32_bf16 v[68:71], v[24:27], v[228:231], 0
    v_mfma_f32_16x16x32_bf16 v[72:75], v[24:27], v[232:235], 0
    v_mfma_f32_16x16x32_bf16 v[76:79], v[24:27], v[236:239], 0
    v_mfma_f32_16x16x32_bf16 v[80:83], v[24:27], v[240:243], 0
    v_mfma_f32_16x16x32_bf16 v[84:87], v[32:35], v[224:227], 0
    v_mfma_f32_16x16x32_bf16 v[88:91], v[32:35], v[228:231], 0
    v_mfma_f32_16x16x32_bf16 v[92:95], v[32:35], v[232:235], 0
    v_mfma_f32_16x16x32_bf16 v[96:99], v[32:35], v[236:239], 0
    v_mfma_f32_16x16x32_bf16 v[100:103], v[32:35], v[240:243], 0
    s_nop 3
    v_cvt_pk_bf16_f32 v64, v64, v65
    v_cvt_pk_bf16_f32 v65, v66, v67
    ds_write_b64 v17, v[64:65] offset:0
    v_cvt_pk_bf16_f32 v68, v68, v69
    v_cvt_pk_bf16_f32 v69, v70, v71
    ds_write_b64 v17, v[68:69] offset:256
    v_cvt_pk_bf16_f32 v72, v72, v73
    v_cvt_pk_bf16_f32 v73, v74, v75
    ds_write_b64 v17, v[72:73] offset:512
    v_cvt_pk_bf16_f32 v76, v76, v77
    v_cvt_pk_bf16_f32 v77, v78, v79
    ds_write_b64 v17, v[76:77] offset:768
    v_cvt_pk_bf16_f32 v80, v80, v81
    v_cvt_pk_bf16_f32 v81, v82, v83
    ds_write_b64 v17, v[80:81] offset:1024
    s_mov_b64 exec, 0xffff
    v_cvt_pk_bf16_f32 v84, v84, v85
    v_cvt_pk_bf16_f32 v85, v86, v87
    ds_write_b64 v18, v[84:85] offset:0
    v_cvt_pk_bf16_f32 v88, v88, v89
    v_cvt_pk_bf16_f32 v89, v90, v91
    ds_write_b64 v18, v[88:89] offset:256
    v_cvt_pk_bf16_f32 v92, v92, v93
    v_cvt_pk_bf16_f32 v93, v94, v95
    ds_write_b64 v18, v[92:93] offset:512
    v_cvt_pk_bf16_f32 v96, v96, v97
    v_cvt_pk_bf16_f32 v97, v98, v99
    ds_write_b64 v18, v[96:97] offset:768
    v_cvt_pk_bf16_f32 v100, v100, v101
    v_cvt_pk_bf16_f32 v101, v102, v103
    ds_write_b64 v18, v[100:101] offset:1024
    s_mov_b64 exec, 1
    ds_write_b32 v23, v245 offset:80
    s_mov_b64 exec, -1
    s_mov_b32 s96, 0
L_lw_74:
    ds_read_b128 v[248:251], v0 offset:80
    s_waitcnt lgkmcnt(0)
    v_min3_u32 v248, v248, v249, v250
    v_min_u32 v248, v248, v251
    s_nop 0
    v_readfirstlane_b32 s90, v248
    s_cmp_ge_i32 s90, 2
    s_cbranch_scc1 L_lwd_75
    s_sleep 0
    s_add_u32 s96, s96, 1
    s_cmp_lt_u32 s96, 2097152
    s_cbranch_scc1 L_lw_74
L_lwd_75:
    ds_read_b128 v[24:27], v21 offset:0
    ds_read_b128 v[28:31], v21 offset:1024
    ds_read_b128 v[32:35], v21 offset:2048
    ds_read_b128 v[36:39], v21 offset:3072
    s_waitcnt lgkmcnt(3)
    buffer_store_dwordx4 v[24:27], v15, s[40:43], s55 offen sc1
    s_waitcnt lgkmcnt(2)
    buffer_store_dwordx4 v[28:31], v15, s[40:43], s56 offen sc1
    s_waitcnt lgkmcnt(1)
    buffer_store_dwordx4 v[32:35], v15, s[40:43], s57 offen sc1
    s_cmp_lg_u32 s51, 0
    s_cbranch_scc1 L_pa_no4
    s_waitcnt lgkmcnt(0)
    s_mov_b64 exec, s[58:59]
    buffer_store_dwordx4 v[36:39], v15, s[40:43], s54 offen sc1
L_pa_no4:
    s_mov_b64 exec, 1
    ds_write_b32 v23, v246 offset:80
    s_mov_b64 exec, -1
    s_branch L_a_sig
L_a_g:
    s_mov_b32 s96, 0
L_ep_76:
    ds_read_b64 v[8:9], v0 offset:32
    s_waitcnt lgkmcnt(0)
    v_readfirstlane_b32 s88, v8
    v_readfirstlane_b32 s89, v9
    s_add_u32 s96, s96, 1
    s_cmp_eq_u32 s88, 0
    s_cselect_b32 s48, s96, -1
    s_cmp_lt_u32 s48, 2097152
    s_cbranch_scc1 L_ep_76
    v_mov_b32 v8, s88
    v_mov_b32 v9, s89
    v_mov_b32 v10, 0
    s_waitcnt vmcnt(0)
    s_mov_b64 exec, 1
    buffer_store_dwordx2 v[8:9], v10, s[40:43], s74 offen sc1
    s_mov_b64 exec, -1
L_a_sig:
    v_mov_b32 v8, 1
    s_lshl_b32 s48, s21, 2
    v_add_u32 v9, s48, v0
    s_mov_b64 exec, 1
    ds_write_b32 v9, v8 offset:48
    s_mov_b64 exec, -1
    s_waitcnt lgkmcnt(0)
    s_mov_b32 s28, s8
    s_mov_b32 s29, s9
    s_mov_b32 s30, 2621440
    s_mov_b32 s31, 0x20000
L_a_main:
    s_setprio 2
    s_and_b32 s18, s2, 7
    s_lshl_b32 s18, s18, 2
    s_lshr_b32 s48, s2, 6
    s_add_u32 s18, s18, s48
    s_bfe_u32 s19, s2, 0x30003
    s_lshr_b32 s48, s18, 1
    s_lshl_b32 s59, s48, 13
    s_add_u32 s59, s59, 15990784
    s_mul_i32 s48, s21, 5
    s_mul_i32 s54, s18, 68
    s_add_u32 s54, s54, s48
    s_add_u32 s54, s54, 48
    s_lshl_b32 s54, s54, 12
    s_mul_i32 s55, s19, 20
    s_add_u32 s55, s55, s48
    s_mul_i32 s55, s55, 5120
    s_add_u32 s55, s55, 11534336
    s_lshl_b32 s53, s18, 8
    s_add_u32 s53, s53, 15728640
    s_lshl_b32 s52, s19, 11
    s_lshl_b32 s49, s21, 9
    s_add_u32 s52, s52, s49
    s_add_u32 s52, s52, 15794176
    s_lshl_b32 s58, s19, 11
    s_add_u32 s58, s58, 15794176
    v_lshlrev_b32 v14, 2, v4
    v_lshlrev_b32 v15, 7, v3
    v_lshrrev_b32 v12, 2, v4
    v_cmp_eq_u32 s[60:61], v12, v3
    v_and_b32 v12, 1, v4
    v_cmp_eq_u32 s[62:63], 0, v12
    s_and_b64 s[64:65], s[60:61], s[62:63]
    s_andn2_b64 s[66:67], s[60:61], s[62:63]
    s_mov_b32 s68, 897988541
    s_mov_b32 s69, 0xffff0000
    s_add_u32 s48, s21, 1
    s_and_b32 s70, s48, 3
    s_add_u32 s48, s21, 2
    s_and_b32 s71, s48, 3
    s_add_u32 s48, s21, 3
    s_and_b32 s72, s48, 3
    s_add_u32 s48, s21, 4
    s_and_b32 s73, s48, 3
    v_lshrrev_b32 v8, 2, v2
    v_and_b32 v9, 3, v2
    v_mul_u32_u24 v24, 80, v8
    v_lshl_add_u32 v24, v9, 4, v24
    v_add_u32 v24, 161280, v24
    v_lshlrev_b32 v26, 7, v8
    v_lshl_add_u32 v26, v9, 4, v26
    s_mul_i32 s78, s19, 102400
    s_and_b32 s49, s18, 3
    s_mul_i32 s49, s49, 25600
    s_add_u32 s78, s78, s49
    s_mul_i32 s49, s21, 6400
    s_add_u32 s78, s78, s49
    s_add_u32 s78, s78, 11534336
    v_lshlrev_b32 v27, 7, v2
    s_mov_b32 s96, 0
L_lw_77:
    ds_read_b32 v8, v0 offset:72
    s_waitcnt lgkmcnt(0)
    v_readfirstlane_b32 s90, v8
    s_cmp_ge_i32 s90, 1
    s_cbranch_scc1 L_lwd_78
    s_sleep 2
    s_add_u32 s96, s96, 1
    s_cmp_lt_u32 s96, 2097152
    s_cbranch_scc1 L_lw_77
L_lwd_78:
    s_cmp_lg_u32 s21, 2
    s_cbranch_scc1 L_a_nopollg
    s_cmp_eq_u32 s20, 0
    s_cbranch_scc1 L_a_nopollg
    s_mov_b32 s96, 0
L_lw_79:
    ds_read_b128 v[8:11], v0 offset:48
    s_waitcnt lgkmcnt(0)
    v_min3_u32 v8, v8, v9, v10
    v_min_u32 v8, v8, v11
    s_nop 0
    v_readfirstlane_b32 s90, v8
    s_cmp_ge_i32 s90, 1
    s_cbranch_scc1 L_lwd_80
    s_sleep 2
    s_add_u32 s96, s96, 1
    s_cmp_lt_u32 s96, 2097152
    s_cbranch_scc1 L_lw_79
L_lwd_80:
    s_mov_b32 s96, 0
    s_mov_b32 s75, 0
L_gp_81:
    s_mov_b32 exec_hi, 0xffff
    buffer_load_dwordx2 v[8:9], v6, s[40:43], s59 offen sc1
    s_waitcnt vmcnt(0)
    v_cmp_ne_u64 vcc, s[88:89], v[8:9]
    s_mov_b32 exec_hi, -1
    s_mov_b32 s74, 0
    s_bfe_u64 s[76:77], vcc, 0xc0000
    s_cselect_b32 s48, 0, 1
    s_or_b32 s74, s74, s48
    s_bfe_u64 s[76:77], vcc, 0xc000c
    s_cselect_b32 s48, 0, 2
    s_or_b32 s74, s74, s48
    s_bfe_u64 s[76:77], vcc, 0xc0018
    s_cselect_b32 s48, 0, 4
    s_or_b32 s74, s74, s48
    s_bfe_u64 s[76:77], vcc, 0xc0024
    s_cselect_b32 s48, 0, 8
    s_or_b32 s74, s74, s48
    s_cmp_eq_u32 s74, s75
    s_cbranch_scc1 L_gs_82
    s_mov_b32 s75, s74
    v_mov_b32 v8, s74
    s_mov_b64 exec, 1
    ds_write_b32 v0, v8 offset:64
    s_mov_b64 exec, -1
L_gs_82:
    s_cmp_eq_u32 s74, 15
    s_cbranch_scc1 L_gd_83
    s_sleep 8
    s_add_u32 s96, s96, 1
    s_cmp_lt_u32 s96, 131072
    s_cbranch_scc1 L_gp_81
L_gd_83:
L_a_nopollg:
    s_lshl_b32 s74, 3, s21
    s_lshr_b32 s74, s74, 1
    s_mov_b32 s96, 0
L_mw_84:
    ds_read_b32 v8, v0 offset:64
    s_waitcnt lgkmcnt(0)
    v_readfirstlane_b32 s90, v8
    s_andn2_b32 s90, s74, s90
    s_cbranch_scc0 L_mwd_85
    s_sleep 2
    s_add_u32 s96, s96, 1
    s_cmp_lt_u32 s96, 2097152
    s_cbranch_scc1 L_mw_84
L_mwd_85:
    s_cmp_eq_u32 s20, 0
    s_cbranch_scc1 L_a_nocp
    s_mul_i32 s49, s19, 2560
    s_add_u32 s48, s54, s49
    v_lshlrev_b32 v8, 7, v2
    s_mov_b64 exec, 0xfffff
    buffer_load_dword v9, v8, s[40:43], s48 offen sc1
    s_mov_b64 exec, -1
    s_waitcnt vmcnt(0)
L_a_nocp:
    s_lshl_b32 s48, s70, 10
    s_add_u32 s56, s54, s48
    buffer_load_dwordx4 v[96:99], v5, s[40:43], s56 offen sc1
    s_add_u32 s56, s56, 4096
    buffer_load_dwordx4 v[112:115], v5, s[40:43], s56 offen sc1
    s_add_u32 s56, s56, 4096
    buffer_load_dwordx4 v[128:131], v5, s[40:43], s56 offen sc1
    s_add_u32 s56, s56, 4096
    buffer_load_dwordx4 v[144:147], v5, s[40:43], s56 offen sc1
    s_add_u32 s56, s56, 4096
    buffer_load_dwordx4 v[160:163], v5, s[40:43], s56 offen sc1
    s_lshl_b32 s48, s71, 10
    s_add_u32 s56, s54, s48
    buffer_load_dwordx4 v[100:103], v5, s[40:43], s56 offen sc1
    s_add_u32 s56, s56, 4096
    buffer_load_dwordx4 v[116:119], v5, s[40:43], s56 offen sc1
    s_add_u32 s56, s56, 4096
    buffer_load_dwordx4 v[132:135], v5, s[40:43], s56 offen sc1
    s_add_u32 s56, s56, 4096
    buffer_load_dwordx4 v[148:151], v5, s[40:43], s56 offen sc1
    s_add_u32 s56, s56, 4096
    buffer_load_dwordx4 v[164:167], v5, s[40:43], s56 offen sc1
    s_lshl_b32 s48, s72, 10
    s_add_u32 s56, s54, s48
    buffer_load_dwordx4 v[104:107], v5, s[40:43], s56 offen sc1
    s_add_u32 s56, s56, 4096
    buffer_load_dwordx4 v[120:123], v5, s[40:43], s56 offen sc1
    s_add_u32 s56, s56, 4096
    buffer_load_dwordx4 v[136:139], v5, s[40:43], s56 offen sc1
    s_add_u32 s56, s56, 4096
    buffer_load_dwordx4 v[152:155], v5, s[40:43], s56 offen sc1
    s_add_u32 s56, s56, 4096
    buffer_load_dwordx4 v[168:171], v5, s[40:43], s56 offen sc1
    s_lshl_b32 s48, s73, 10
    s_add_u32 s56, s54, s48
    buffer_load_dwordx4 v[108:111], v5, s[40:43], s56 offen sc1
    s_add_u32 s56, s56, 4096
    buffer_load_dwordx4 v[124:127], v5, s[40:43], s56 offen sc1
    s_add_u32 s56, s56, 4096
    buffer_load_dwordx4 v[140:143], v5, s[40:43], s56 offen sc1
    s_add_u32 s56, s56, 4096
    buffer_load_dwordx4 v[156:159], v5, s[40:43], s56 offen sc1
    s_add_u32 s56, s56, 4096
    buffer_load_dwordx4 v[172:175], v5, s[40:43], s56 offen sc1
    s_mov_b32 s96, 0
L_mw_86:
    ds_read_b32 v8, v0 offset:64
    s_waitcnt lgkmcnt(0)
    v_readfirstlane_b32 s90, v8
    s_andn2_b32 s90, 8, s90
    s_cbranch_scc0 L_mwd_87
    s_sleep 2
    s_add_u32 s96, s96, 1
    s_cmp_lt_u32 s96, 2097152
    s_cbranch_scc1 L_mw_86
L_mwd_87:
    s_lshl_b32 s48, s70, 6
    s_add_u32 s56, s53, s48
    buffer_load_dword v10, v14, s[40:43], s56 offen sc1
    s_lshl_b32 s48, s71, 6
    s_add_u32 s56, s53, s48
    buffer_load_dword v11, v14, s[40:43], s56 offen sc1
    s_lshl_b32 s48, s72, 6
    s_add_u32 s56, s53, s48
    buffer_load_dword v12, v14, s[40:43], s56 offen sc1
    s_lshl_b32 s48, s73, 6
    s_add_u32 s56, s53, s48
    buffer_load_dword v13, v14, s[40:43], s56 offen sc1
    s_cmp_lg_u32 s21, 1
    s_cbranch_scc1 L_a_oth2
L_a_nogate:
    buffer_load_dwordx4 v[16:19], v26, s[40:43], s58 offen sc1
    buffer_load_dwordx4 v[20:23], v26, s[40:43], s58 offen offset:16 sc1
L_a_oth2:
    s_cmp_lg_u32 s21, 1
    s_cbranch_scc1 L_a_nopoll
    s_mov_b32 s96, 0
    s_waitcnt vmcnt(0)
    s_branch L_a_zchk
L_a_zpoll:
    buffer_load_dwordx4 v[16:19], v26, s[40:43], s58 offen sc1
    buffer_load_dwordx4 v[20:23], v26, s[40:43], s58 offen offset:16 sc1
    s_waitcnt vmcnt(0)
L_a_zchk:
    v_max3_u32 v9, v16, v18, v20
    v_max_u32 v9, v9, v22
    v_cmp_eq_u32 vcc, -1, v9
    s_cbranch_vccz L_a_zok
    s_sleep 4
    s_add_u32 s96, s96, 1
    s_cmp_lt_u32 s96, 131072
    s_cbranch_scc1 L_a_zpoll
L_a_zok:
    ds_write_b128 v24, v[16:19]
    ds_write_b128 v24, v[20:23] offset:16
    v_mov_b32 v8, 1
    s_mov_b64 exec, 1
    ds_write_b32 v0, v8 offset:68
    s_mov_b64 exec, -1
L_a_nopoll:
    s_mul_i32 s48, s21, 320
    s_add_u32 s48, s48, 161280
    v_mul_u32_u24 v15, 80, v3
    v_add_u32 v15, s48, v15
    s_mov_b32 s96, 0
L_lw_88:
    ds_read_b32 v8, v0 offset:68
    s_waitcnt lgkmcnt(0)
    v_readfirstlane_b32 s90, v8
    s_cmp_ge_i32 s90, 1
    s_cbranch_scc1 L_lwd_89
    s_sleep 2
    s_add_u32 s96, s96, 1
    s_cmp_lt_u32 s96, 2097152
    s_cbranch_scc1 L_lw_88
L_lwd_89:
    ds_read_b128 v[236:239], v15 offset:0
    ds_read_b128 v[240:243], v15 offset:16
    ds_read_b128 v[244:247], v15 offset:32
    ds_read_b128 v[248:251], v15 offset:48
    ds_read_b128 v[252:255], v15 offset:64
    s_waitcnt vmcnt(0)
    v_mov_b32 v94, v27
    s_waitcnt lgkmcnt(0)
    v_cndmask_b32 v236, 0, v236, s[64:65]
    v_cndmask_b32 v237, 0, v237, s[64:65]
    v_cndmask_b32 v238, 0, v238, s[64:65]
    v_cndmask_b32 v239, 0, v239, s[64:65]
    v_cndmask_b32 v240, 0, v240, s[64:65]
    v_cndmask_b32 v241, 0, v241, s[64:65]
    v_cndmask_b32 v242, 0, v242, s[64:65]
    v_cndmask_b32 v243, 0, v243, s[64:65]
    v_cndmask_b32 v244, 0, v244, s[64:65]
    v_cndmask_b32 v245, 0, v245, s[64:65]
    v_cndmask_b32 v246, 0, v246, s[66:67]
    v_cndmask_b32 v247, 0, v247, s[66:67]
    v_cndmask_b32 v248, 0, v248, s[66:67]
    v_cndmask_b32 v249, 0, v249, s[66:67]
    v_cndmask_b32 v250, 0, v250, s[66:67]
    v_cndmask_b32 v251, 0, v251, s[66:67]
    v_cndmask_b32 v252, 0, v252, s[66:67]
    v_cndmask_b32 v253, 0, v253, s[66:67]
    v_cndmask_b32 v254, 0, v254, s[66:67]
    v_cndmask_b32 v255, 0, v255, s[66:67]
    s_nop 0
    v_mfma_f32_16x16x32_bf16 v[16:19], v[236:239], v[96:99], 0
    v_mfma_f32_16x16x32_bf16 v[20:23], v[236:239], v[100:103], 0
    v_mfma_f32_16x16x32_bf16 v[24:27], v[236:239], v[104:107], 0
    v_mfma_f32_16x16x32_bf16 v[28:31], v[236:239], v[108:111], 0
    v_mfma_f32_16x16x32_bf16 v[16:19], v[240:243], v[112:115], v[16:19]
    v_mfma_f32_16x16x32_bf16 v[20:23], v[240:243], v[116:119], v[20:23]
    v_mfma_f32_16x16x32_bf16 v[24:27], v[240:243], v[120:123], v[24:27]
    v_mfma_f32_16x16x32_bf16 v[28:31], v[240:243], v[124:127], v[28:31]
    v_mfma_f32_16x16x32_bf16 v[16:19], v[244:247], v[128:131], v[16:19]
    v_mfma_f32_16x16x32_bf16 v[20:23], v[244:247], v[132:135], v[20:23]
    v_mfma_f32_16x16x32_bf16 v[24:27], v[244:247], v[136:139], v[24:27]
    v_mfma_f32_16x16x32_bf16 v[28:31], v[244:247], v[140:143], v[28:31]
    v_mfma_f32_16x16x32_bf16 v[16:19], v[248:251], v[144:147], v[16:19]
    v_mfma_f32_16x16x32_bf16 v[20:23], v[248:251], v[148:151], v[20:23]
    v_mfma_f32_16x16x32_bf16 v[24:27], v[248:251], v[152:155], v[24:27]
    v_mfma_f32_16x16x32_bf16 v[28:31], v[248:251], v[156:159], v[28:31]
    v_mfma_f32_16x16x32_bf16 v[16:19], v[252:255], v[160:163], v[16:19]
    v_mfma_f32_16x16x32_bf16 v[20:23], v[252:255], v[164:167], v[20:23]
    v_mfma_f32_16x16x32_bf16 v[24:27], v[252:255], v[168:171], v[24:27]
    v_mfma_f32_16x16x32_bf16 v[28:31], v[252:255], v[172:175], v[28:31]
    s_nop 7
    v_add_f32 v16, s68, v16
    v_add_f32 v17, s68, v17
    v_add_f32 v20, s68, v20
    v_add_f32 v21, s68, v21
    v_add_f32 v24, s68, v24
    v_add_f32 v25, s68, v25
    v_add_f32 v28, s68, v28
    v_add_f32 v29, s68, v29
    v_rcp_f32 v16, v16
    v_rcp_f32 v17, v17
    v_rcp_f32 v20, v20
    v_rcp_f32 v21, v21
    v_rcp_f32 v24, v24
    v_rcp_f32 v25, v25
    v_rcp_f32 v28, v28
    v_rcp_f32 v29, v29
    s_nop 0
    v_mul_f32 v236, v10, v16
    v_mul_f32 v237, v10, v17
    v_mul_f32 v238, v11, v20
    v_mul_f32 v239, v11, v21
    v_mul_f32 v240, v12, v24
    v_mul_f32 v241, v12, v25
    v_mul_f32 v242, v13, v28
    v_mul_f32 v243, v13, v29
    v_lshlrev_b32 v244, 16, v96
    v_and_b32 v245, s69, v96
    v_lshlrev_b32 v246, 16, v97
    v_and_b32 v247, s69, v97
    v_lshlrev_b32 v248, 16, v98
    v_and_b32 v249, s69, v98
    v_lshlrev_b32 v250, 16, v99
    v_and_b32 v251, s69, v99
    v_mul_f32 v244, v236, v244
    v_mul_f32 v245, v236, v245
    v_mul_f32 v246, v236, v246
    v_mul_f32 v247, v236, v247
    v_mul_f32 v248, v236, v248
    v_mul_f32 v249, v236, v249
    v_mul_f32 v250, v236, v250
    v_mul_f32 v251, v236, v251
    v_cvt_pk_bf16_f32 v96, v244, v245
    v_cvt_pk_bf16_f32 v97, v246, v247
    v_cvt_pk_bf16_f32 v98, v248, v249
    v_cvt_pk_bf16_f32 v99, v250, v251
    v_lshlrev_b32 v244, 16, v100
    v_and_b32 v245, s69, v100
    v_lshlrev_b32 v246, 16, v101
    v_and_b32 v247, s69, v101
    v_lshlrev_b32 v248, 16, v102
    v_and_b32 v249, s69, v102
    v_lshlrev_b32 v250, 16, v103
    v_and_b32 v251, s69, v103
    v_mul_f32 v244, v238, v244
    v_mul_f32 v245, v238, v245
    v_mul_f32 v246, v238, v246
    v_mul_f32 v247, v238, v247
    v_mul_f32 v248, v238, v248
    v_mul_f32 v249, v238, v249
    v_mul_f32 v250, v238, v250
    v_mul_f32 v251, v238, v251
    v_cvt_pk_bf16_f32 v100, v244, v245
    v_cvt_pk_bf16_f32 v101, v246, v247
    v_cvt_pk_bf16_f32 v102, v248, v249
    v_cvt_pk_bf16_f32 v103, v250, v251
    v_lshlrev_b32 v244, 16, v104
    v_and_b32 v245, s69, v104
    v_lshlrev_b32 v246, 16, v105
    v_and_b32 v247, s69, v105
    v_lshlrev_b32 v248, 16, v106
    v_and_b32 v249, s69, v106
    v_lshlrev_b32 v250, 16, v107
    v_and_b32 v251, s69, v107
    v_mul_f32 v244, v240, v244
    v_mul_f32 v245, v240, v245
    v_mul_f32 v246, v240, v246
    v_mul_f32 v247, v240, v247
    v_mul_f32 v248, v240, v248
    v_mul_f32 v249, v240, v249
    v_mul_f32 v250, v240, v250
    v_mul_f32 v251, v240, v251
    v_cvt_pk_bf16_f32 v104, v244, v245
    v_cvt_pk_bf16_f32 v105, v246, v247
    v_cvt_pk_bf16_f32 v106, v248, v249
    v_cvt_pk_bf16_f32 v107, v250, v251
    v_lshlrev_b32 v244, 16, v108
    v_and_b32 v245, s69, v108
    v_lshlrev_b32 v246, 16, v109
    v_and_b32 v247, s69, v109
    v_lshlrev_b32 v248, 16, v110
    v_and_b32 v249, s69, v110
    v_lshlrev_b32 v250, 16, v111
    v_and_b32 v251, s69, v111
    v_mul_f32 v244, v242, v244
    v_mul_f32 v245, v242, v245
    v_mul_f32 v246, v242, v246
    v_mul_f32 v247, v242, v247
    v_mul_f32 v248, v242, v248
    v_mul_f32 v249, v242, v249
    v_mul_f32 v250, v242, v250
    v_mul_f32 v251, v242, v251
    v_cvt_pk_bf16_f32 v108, v244, v245
    v_cvt_pk_bf16_f32 v109, v246, v247
    v_cvt_pk_bf16_f32 v110, v248, v249
    v_cvt_pk_bf16_f32 v111, v250, v251
    v_lshlrev_b32 v244, 16, v112
    v_and_b32 v245, s69, v112
    v_lshlrev_b32 v246, 16, v113
    v_and_b32 v247, s69, v113
    v_lshlrev_b32 v248, 16, v114
    v_and_b32 v249, s69, v114
    v_lshlrev_b32 v250, 16, v115
    v_and_b32 v251, s69, v115
    v_mul_f32 v244, v236, v244
    v_mul_f32 v245, v236, v245
    v_mul_f32 v246, v236, v246
    v_mul_f32 v247, v236, v247
    v_mul_f32 v248, v236, v248
    v_mul_f32 v249, v236, v249
    v_mul_f32 v250, v236, v250
    v_mul_f32 v251, v236, v251
    v_cvt_pk_bf16_f32 v112, v244, v245
    v_cvt_pk_bf16_f32 v113, v246, v247
    v_cvt_pk_bf16_f32 v114, v248, v249
    v_cvt_pk_bf16_f32 v115, v250, v251
    v_lshlrev_b32 v244, 16, v116
    v_and_b32 v245, s69, v116
    v_lshlrev_b32 v246, 16, v117
    v_and_b32 v247, s69, v117
    v_lshlrev_b32 v248, 16, v118
    v_and_b32 v249, s69, v118
    v_lshlrev_b32 v250, 16, v119
    v_and_b32 v251, s69, v119
    v_mul_f32 v244, v238, v244
    v_mul_f32 v245, v238, v245
    v_mul_f32 v246, v238, v246
    v_mul_f32 v247, v238, v247
    v_mul_f32 v248, v238, v248
    v_mul_f32 v249, v238, v249
    v_mul_f32 v250, v238, v250
    v_mul_f32 v251, v238, v251
    v_cvt_pk_bf16_f32 v116, v244, v245
    v_cvt_pk_bf16_f32 v117, v246, v247
    v_cvt_pk_bf16_f32 v118, v248, v249
    v_cvt_pk_bf16_f32 v119, v250, v251
    v_lshlrev_b32 v244, 16, v120
    v_and_b32 v245, s69, v120
    v_lshlrev_b32 v246, 16, v121
    v_and_b32 v247, s69, v121
    v_lshlrev_b32 v248, 16, v122
    v_and_b32 v249, s69, v122
    v_lshlrev_b32 v250, 16, v123
    v_and_b32 v251, s69, v123
    v_mul_f32 v244, v240, v244
    v_mul_f32 v245, v240, v245
    v_mul_f32 v246, v240, v246
    v_mul_f32 v247, v240, v247
    v_mul_f32 v248, v240, v248
    v_mul_f32 v249, v240, v249
    v_mul_f32 v250, v240, v250
    v_mul_f32 v251, v240, v251
    v_cvt_pk_bf16_f32 v120, v244, v245
    v_cvt_pk_bf16_f32 v121, v246, v247
    v_cvt_pk_bf16_f32 v122, v248, v249
    v_cvt_pk_bf16_f32 v123, v250, v251
    v_lshlrev_b32 v244, 16, v124
    v_and_b32 v245, s69, v124
    v_lshlrev_b32 v246, 16, v125
    v_and_b32 v247, s69, v125
    v_lshlrev_b32 v248, 16, v126
    v_and_b32 v249, s69, v126
    v_lshlrev_b32 v250, 16, v127
    v_and_b32 v251, s69, v127
    v_mul_f32 v244, v242, v244
    v_mul_f32 v245, v242, v245
    v_mul_f32 v246, v242, v246
    v_mul_f32 v247, v242, v247
    v_mul_f32 v248, v242, v248
    v_mul_f32 v249, v242, v249
    v_mul_f32 v250, v242, v250
    v_mul_f32 v251, v242, v251
    v_cvt_pk_bf16_f32 v124, v244, v245
    v_cvt_pk_bf16_f32 v125, v246, v247
    v_cvt_pk_bf16_f32 v126, v248, v249
    v_cvt_pk_bf16_f32 v127, v250, v251
    s_mov_b32 exec_hi, 0x3ffff
    buffer_load_dword v95, v94, s[40:43], s78 offen sc1
    s_mov_b64 exec, -1
    v_lshlrev_b32 v244, 16, v128
    v_and_b32 v245, s69, v128
    v_lshlrev_b32 v246, 16, v129
    v_and_b32 v247, s69, v129
    v_lshlrev_b32 v248, 16, v130
    v_and_b32 v249, s69, v130
    v_lshlrev_b32 v250, 16, v131
    v_and_b32 v251, s69, v131
    v_mul_f32 v244, v236, v244
    v_mul_f32 v245, v236, v245
    v_mul_f32 v246, v236, v246
    v_mul_f32 v247, v236, v247
    v_mul_f32 v248, v237, v248
    v_mul_f32 v249, v237, v249
    v_mul_f32 v250, v237, v250
    v_mul_f32 v251, v237, v251
    v_cvt_pk_bf16_f32 v128, v244, v245
    v_cvt_pk_bf16_f32 v129, v246, v247
    v_cvt_pk_bf16_f32 v130, v248, v249
    v_cvt_pk_bf16_f32 v131, v250, v251
    v_lshlrev_b32 v244, 16, v132
    v_and_b32 v245, s69, v132
    v_lshlrev_b32 v246, 16, v133
    v_and_b32 v247, s69, v133
    v_lshlrev_b32 v248, 16, v134
    v_and_b32 v249, s69, v134
    v_lshlrev_b32 v250, 16, v135
    v_and_b32 v251, s69, v135
    v_mul_f32 v244, v238, v244
    v_mul_f32 v245, v238, v245
    v_mul_f32 v246, v238, v246
    v_mul_f32 v247, v238, v247
    v_mul_f32 v248, v239, v248
    v_mul_f32 v249, v239, v249
    v_mul_f32 v250, v239, v250
    v_mul_f32 v251, v239, v251
    v_cvt_pk_bf16_f32 v132, v244, v245
    v_cvt_pk_bf16_f32 v133, v246, v247
    v_cvt_pk_bf16_f32 v134, v248, v249
    v_cvt_pk_bf16_f32 v135, v250, v251
    v_lshlrev_b32 v244, 16, v136
    v_and_b32 v245, s69, v136
    v_lshlrev_b32 v246, 16, v137
    v_and_b32 v247, s69, v137
    v_lshlrev_b32 v248, 16, v138
    v_and_b32 v249, s69, v138
    v_lshlrev_b32 v250, 16, v139
    v_and_b32 v251, s69, v139
    v_mul_f32 v244, v240, v244
    v_mul_f32 v245, v240, v245
    v_mul_f32 v246, v240, v246
    v_mul_f32 v247, v240, v247
    v_mul_f32 v248, v241, v248
    v_mul_f32 v249, v241, v249
    v_mul_f32 v250, v241, v250
    v_mul_f32 v251, v241, v251
    v_cvt_pk_bf16_f32 v136, v244, v245
    v_cvt_pk_bf16_f32 v137, v246, v247
    v_cvt_pk_bf16_f32 v138, v248, v249
    v_cvt_pk_bf16_f32 v139, v250, v251
    v_lshlrev_b32 v244, 16, v140
    v_and_b32 v245, s69, v140
    v_lshlrev_b32 v246, 16, v141
    v_and_b32 v247, s69, v141
    v_lshlrev_b32 v248, 16, v142
    v_and_b32 v249, s69, v142
    v_lshlrev_b32 v250, 16, v143
    v_and_b32 v251, s69, v143
    v_mul_f32 v244, v242, v244
    v_mul_f32 v245, v242, v245
    v_mul_f32 v246, v242, v246
    v_mul_f32 v247, v242, v247
    v_mul_f32 v248, v243, v248
    v_mul_f32 v249, v243, v249
    v_mul_f32 v250, v243, v250
    v_mul_f32 v251, v243, v251
    v_cvt_pk_bf16_f32 v140, v244, v245
    v_cvt_pk_bf16_f32 v141, v246, v247
    v_cvt_pk_bf16_f32 v142, v248, v249
    v_cvt_pk_bf16_f32 v143, v250, v251
    v_lshlrev_b32 v244, 16, v144
    v_and_b32 v245, s69, v144
    v_lshlrev_b32 v246, 16, v145
    v_and_b32 v247, s69, v145
    v_lshlrev_b32 v248, 16, v146
    v_and_b32 v249, s69, v146
    v_lshlrev_b32 v250, 16, v147
    v_and_b32 v251, s69, v147
    v_mul_f32 v244, v237, v244
    v_mul_f32 v245, v237, v245
    v_mul_f32 v246, v237, v246
    v_mul_f32 v247, v237, v247
    v_mul_f32 v248, v237, v248
    v_mul_f32 v249, v237, v249
    v_mul_f32 v250, v237, v250
    v_mul_f32 v251, v237, v251
    v_cvt_pk_bf16_f32 v144, v244, v245
    v_cvt_pk_bf16_f32 v145, v246, v247
    v_cvt_pk_bf16_f32 v146, v248, v249
    v_cvt_pk_bf16_f32 v147, v250, v251
    v_lshlrev_b32 v244, 16, v148
    v_and_b32 v245, s69, v148
    v_lshlrev_b32 v246, 16, v149
    v_and_b32 v247, s69, v149
    v_lshlrev_b32 v248, 16, v150
    v_and_b32 v249, s69, v150
    v_lshlrev_b32 v250, 16, v151
    v_and_b32 v251, s69, v151
    v_mul_f32 v244, v239, v244
    v_mul_f32 v245, v239, v245
    v_mul_f32 v246, v239, v246
    v_mul_f32 v247, v239, v247
    v_mul_f32 v248, v239, v248
    v_mul_f32 v249, v239, v249
    v_mul_f32 v250, v239, v250
    v_mul_f32 v251, v239, v251
    v_cvt_pk_bf16_f32 v148, v244, v245
    v_cvt_pk_bf16_f32 v149, v246, v247
    v_cvt_pk_bf16_f32 v150, v248, v249
    v_cvt_pk_bf16_f32 v151, v250, v251
    v_lshlrev_b32 v244, 16, v152
    v_and_b32 v245, s69, v152
    v_lshlrev_b32 v246, 16, v153
    v_and_b32 v247, s69, v153
    v_lshlrev_b32 v248, 16, v154
    v_and_b32 v249, s69, v154
    v_lshlrev_b32 v250, 16, v155
    v_and_b32 v251, s69, v155
    v_mul_f32 v244, v241, v244
    v_mul_f32 v245, v241, v245
    v_mul_f32 v246, v241, v246
    v_mul_f32 v247, v241, v247
    v_mul_f32 v248, v241, v248
    v_mul_f32 v249, v241, v249
    v_mul_f32 v250, v241, v250
    v_mul_f32 v251, v241, v251
    v_cvt_pk_bf16_f32 v152, v244, v245
    v_cvt_pk_bf16_f32 v153, v246, v247
    v_cvt_pk_bf16_f32 v154, v248, v249
    v_cvt_pk_bf16_f32 v155, v250, v251
    v_lshlrev_b32 v244, 16, v156
    v_and_b32 v245, s69, v156
    v_lshlrev_b32 v246, 16, v157
    v_and_b32 v247, s69, v157
    v_lshlrev_b32 v248, 16, v158
    v_and_b32 v249, s69, v158
    v_lshlrev_b32 v250, 16, v159
    v_and_b32 v251, s69, v159
    v_mul_f32 v244, v243, v244
    v_mul_f32 v245, v243, v245
    v_mul_f32 v246, v243, v246
    v_mul_f32 v247, v243, v247
    v_mul_f32 v248, v243, v248
    v_mul_f32 v249, v243, v249
    v_mul_f32 v250, v243, v250
    v_mul_f32 v251, v243, v251
    v_cvt_pk_bf16_f32 v156, v244, v245
    v_cvt_pk_bf16_f32 v157, v246, v247
    v_cvt_pk_bf16_f32 v158, v248, v249
    v_cvt_pk_bf16_f32 v159, v250, v251
    s_waitcnt vmcnt(0)
    s_add_u32 s57, s55, 0
    buffer_load_dwordx4 v[176:179], v5, s[40:43], s57 offen offset:0 sc1
    buffer_load_dwordx4 v[180:183], v5, s[40:43], s57 offen offset:1024 sc1
    buffer_load_dwordx4 v[184:187], v5, s[40:43], s57 offen offset:2048 sc1
    buffer_load_dwordx4 v[188:191], v5, s[40:43], s57 offen offset:3072 sc1
    buffer_load_dwordx4 v[192:195], v7, s[40:43], s57 offen sc1
    s_add_u32 s57, s55, 5120
    buffer_load_dwordx4 v[196:199], v5, s[40:43], s57 offen offset:0 sc1
    buffer_load_dwordx4 v[200:203], v5, s[40:43], s57 offen offset:1024 sc1
    buffer_load_dwordx4 v[204:207], v5, s[40:43], s57 offen offset:2048 sc1
    buffer_load_dwordx4 v[208:211], v5, s[40:43], s57 offen offset:3072 sc1
    buffer_load_dwordx4 v[212:215], v7, s[40:43], s57 offen sc1
    v_lshlrev_b32 v244, 16, v160
    v_and_b32 v245, s69, v160
    v_lshlrev_b32 v246, 16, v161
    v_and_b32 v247, s69, v161
    v_lshlrev_b32 v248, 16, v162
    v_and_b32 v249, s69, v162
    v_lshlrev_b32 v250, 16, v163
    v_and_b32 v251, s69, v163
    v_mul_f32 v244, v237, v244
    v_mul_f32 v245, v237, v245
    v_mul_f32 v246, v237, v246
    v_mul_f32 v247, v237, v247
    v_mul_f32 v248, v237, v248
    v_mul_f32 v249, v237, v249
    v_mul_f32 v250, v237, v250
    v_mul_f32 v251, v237, v251
    v_cvt_pk_bf16_f32 v160, v244, v245
    v_cvt_pk_bf16_f32 v161, v246, v247
    v_cvt_pk_bf16_f32 v162, v248, v249
    v_cvt_pk_bf16_f32 v163, v250, v251
    v_lshlrev_b32 v244, 16, v164
    v_and_b32 v245, s69, v164
    v_lshlrev_b32 v246, 16, v165
    v_and_b32 v247, s69, v165
    v_lshlrev_b32 v248, 16, v166
    v_and_b32 v249, s69, v166
    v_lshlrev_b32 v250, 16, v167
    v_and_b32 v251, s69, v167
    v_mul_f32 v244, v239, v244
    v_mul_f32 v245, v239, v245
    v_mul_f32 v246, v239, v246
    v_mul_f32 v247, v239, v247
    v_mul_f32 v248, v239, v248
    v_mul_f32 v249, v239, v249
    v_mul_f32 v250, v239, v250
    v_mul_f32 v251, v239, v251
    v_cvt_pk_bf16_f32 v164, v244, v245
    v_cvt_pk_bf16_f32 v165, v246, v247
    v_cvt_pk_bf16_f32 v166, v248, v249
    v_cvt_pk_bf16_f32 v167, v250, v251
    v_lshlrev_b32 v244, 16, v168
    v_and_b32 v245, s69, v168
    v_lshlrev_b32 v246, 16, v169
    v_and_b32 v247, s69, v169
    v_lshlrev_b32 v248, 16, v170
    v_and_b32 v249, s69, v170
    v_lshlrev_b32 v250, 16, v171
    v_and_b32 v251, s69, v171
    v_mul_f32 v244, v241, v244
    v_mul_f32 v245, v241, v245
    v_mul_f32 v246, v241, v246
    v_mul_f32 v247, v241, v247
    v_mul_f32 v248, v241, v248
    v_mul_f32 v249, v241, v249
    v_mul_f32 v250, v241, v250
    v_mul_f32 v251, v241, v251
    v_cvt_pk_bf16_f32 v168, v244, v245
    v_cvt_pk_bf16_f32 v169, v246, v247
    v_cvt_pk_bf16_f32 v170, v248, v249
    v_cvt_pk_bf16_f32 v171, v250, v251
    v_lshlrev_b32 v244, 16, v172
    v_and_b32 v245, s69, v172
    v_lshlrev_b32 v246, 16, v173
    v_and_b32 v247, s69, v173
    v_lshlrev_b32 v248, 16, v174
    v_and_b32 v249, s69, v174
    v_lshlrev_b32 v250, 16, v175
    v_and_b32 v251, s69, v175
    v_mul_f32 v244, v243, v244
    v_mul_f32 v245, v243, v245
    v_mul_f32 v246, v243, v246
    v_mul_f32 v247, v243, v247
    v_mul_f32 v248, v243, v248
    v_mul_f32 v249, v243, v249
    v_mul_f32 v250, v243, v250
    v_mul_f32 v251, v243, v251
    v_cvt_pk_bf16_f32 v172, v244, v245
    v_cvt_pk_bf16_f32 v173, v246, v247
    v_cvt_pk_bf16_f32 v174, v248, v249
    v_cvt_pk_bf16_f32 v175, v250, v251
    s_add_u32 s57, s55, 10240
    buffer_load_dwordx4 v[216:219], v5, s[40:43], s57 offen offset:0 sc1
    buffer_load_dwordx4 v[220:223], v5, s[40:43], s57 offen offset:1024 sc1
    buffer_load_dwordx4 v[224:227], v5, s[40:43], s57 offen offset:2048 sc1
    buffer_load_dwordx4 v[228:231], v5, s[40:43], s57 offen offset:3072 sc1
    buffer_load_dwordx4 v[232:235], v7, s[40:43], s57 offen sc1
    v_sub_f32 v14, 1.0, v13
    s_mul_i32 s48, s70, 15360
    s_cmp_eq_u32 s70, 3
    s_cselect_b32 s48, 131072, s48
    s_add_u32 s48, s48, 10240
    v_add_u32 v10, s48, v5
    s_mul_i32 s48, s71, 15360
    s_cmp_eq_u32 s71, 3
    s_cselect_b32 s48, 131072, s48
    s_add_u32 s48, s48, 5120
    v_add_u32 v11, s48, v5
    s_mul_i32 s48, s72, 15360
    s_cmp_eq_u32 s72, 3
    s_cselect_b32 s48, 131072, s48
    s_add_u32 s48, s48, 0
    v_add_u32 v12, s48, v5
    s_lshl_b32 s48, s21, 11
    s_add_u32 s48, s48, 143360
    v_add_u32 v13, s48, v5
    s_mul_i32 s48, s21, 5120
    s_add_u32 s48, s48, 90112
    v_add_u32 v15, s48, v5
    s_lshl_b32 s48, s21, 2
    v_add_u32 v6, s48, v0
    s_waitcnt vmcnt(10)
    v_max3_u32 v8, v176, v178, v180
    v_max3_u32 v8, v8, v182, v184
    v_max3_u32 v8, v8, v186, v188
    v_max3_u32 v8, v8, v190, v192
    v_max_u32 v8, v8, v194
    v_cmp_eq_u32 vcc, -1, v8
    s_cbranch_vccnz L_a_mre0
L_a_mok0:
    v_mfma_f32_16x16x32_bf16 v[16:19], v[176:179], v[96:99], 0
    v_mfma_f32_16x16x32_bf16 v[20:23], v[180:183], v[96:99], 0
    v_mfma_f32_16x16x32_bf16 v[24:27], v[184:187], v[96:99], 0
    v_mfma_f32_16x16x32_bf16 v[28:31], v[188:191], v[96:99], 0
    v_mfma_f32_16x16x32_bf16 v[32:35], v[192:195], v[96:99], 0
    v_mfma_f32_16x16x32_bf16 v[36:39], v[176:179], v[100:103], 0
    v_mfma_f32_16x16x32_bf16 v[40:43], v[180:183], v[100:103], 0
    v_mfma_f32_16x16x32_bf16 v[44:47], v[184:187], v[100:103], 0
    v_mfma_f32_16x16x32_bf16 v[48:51], v[188:191], v[100:103], 0
    v_mfma_f32_16x16x32_bf16 v[52:55], v[192:195], v[100:103], 0
    v_mfma_f32_16x16x32_bf16 v[56:59], v[176:179], v[104:107], 0
    v_mfma_f32_16x16x32_bf16 v[60:63], v[180:183], v[104:107], 0
    v_mfma_f32_16x16x32_bf16 v[64:67], v[184:187], v[104:107], 0
    v_mfma_f32_16x16x32_bf16 v[68:71], v[188:191], v[104:107], 0
    s_waitcnt vmcnt(5)
    v_max3_u32 v8, v196, v198, v200
    v_mfma_f32_16x16x32_bf16 v[72:75], v[192:195], v[104:107], 0
    v_max3_u32 v8, v8, v202, v204
    v_mfma_f32_16x16x32_bf16 v[76:79], v[176:179], v[108:111], 0
    v_max3_u32 v8, v8, v206, v208
    v_mfma_f32_16x16x32_bf16 v[80:83], v[180:183], v[108:111], 0
    v_max3_u32 v8, v8, v210, v212
    v_mfma_f32_16x16x32_bf16 v[84:87], v[184:187], v[108:111], 0
    v_max_u32 v8, v8, v214
    v_mfma_f32_16x16x32_bf16 v[88:91], v[188:191], v[108:111], 0
    v_cmp_eq_u32 vcc, -1, v8
    v_mfma_f32_16x16x32_bf16 v[92:95], v[192:195], v[108:111], 0
    s_add_u32 s57, s55, 15360
    buffer_load_dwordx4 v[176:179], v5, s[40:43], s57 offen offset:0 sc1
    buffer_load_dwordx4 v[180:183], v5, s[40:43], s57 offen offset:1024 sc1
    buffer_load_dwordx4 v[184:187], v5, s[40:43], s57 offen offset:2048 sc1
    buffer_load_dwordx4 v[188:191], v5, s[40:43], s57 offen offset:3072 sc1
    buffer_load_dwordx4 v[192:195], v7, s[40:43], s57 offen sc1
    s_cbranch_vccnz L_a_mre1
L_a_mok1:
    v_mfma_f32_16x16x32_bf16 v[16:19], v[196:199], v[112:115], v[16:19]
    v_mfma_f32_16x16x32_bf16 v[20:23], v[200:203], v[112:115], v[20:23]
    v_mfma_f32_16x16x32_bf16 v[24:27], v[204:207], v[112:115], v[24:27]
    v_mfma_f32_16x16x32_bf16 v[28:31], v[208:211], v[112:115], v[28:31]
    v_mfma_f32_16x16x32_bf16 v[32:35], v[212:215], v[112:115], v[32:35]
    v_mfma_f32_16x16x32_bf16 v[36:39], v[196:199], v[116:119], v[36:39]
    v_mfma_f32_16x16x32_bf16 v[40:43], v[200:203], v[116:119], v[40:43]
    v_mfma_f32_16x16x32_bf16 v[44:47], v[204:207], v[116:119], v[44:47]
    v_mfma_f32_16x16x32_bf16 v[48:51], v[208:211], v[116:119], v[48:51]
    v_mfma_f32_16x16x32_bf16 v[52:55], v[212:215], v[116:119], v[52:55]
    v_mfma_f32_16x16x32_bf16 v[56:59], v[196:199], v[120:123], v[56:59]
    v_mfma_f32_16x16x32_bf16 v[60:63], v[200:203], v[120:123], v[60:63]
    v_mfma_f32_16x16x32_bf16 v[64:67], v[204:207], v[120:123], v[64:67]
    v_mfma_f32_16x16x32_bf16 v[68:71], v[208:211], v[120:123], v[68:71]
    s_waitcnt vmcnt(5)
    v_max3_u32 v8, v216, v218, v220
    v_mfma_f32_16x16x32_bf16 v[72:75], v[212:215], v[120:123], v[72:75]
    v_max3_u32 v8, v8, v222, v224
    v_mfma_f32_16x16x32_bf16 v[76:79], v[196:199], v[124:127], v[76:79]
    v_max3_u32 v8, v8, v226, v228
    v_mfma_f32_16x16x32_bf16 v[80:83], v[200:203], v[124:127], v[80:83]
    v_max3_u32 v8, v8, v230, v232
    v_mfma_f32_16x16x32_bf16 v[84:87], v[204:207], v[124:127], v[84:87]
    v_max_u32 v8, v8, v234
    v_mfma_f32_16x16x32_bf16 v[88:91], v[208:211], v[124:127], v[88:91]
    v_cmp_eq_u32 vcc, -1, v8
    v_mfma_f32_16x16x32_bf16 v[92:95], v[212:215], v[124:127], v[92:95]
    s_add_u32 s57, s55, 20480
    buffer_load_dwordx4 v[196:199], v5, s[40:43], s57 offen offset:0 sc1
    buffer_load_dwordx4 v[200:203], v5, s[40:43], s57 offen offset:1024 sc1
    buffer_load_dwordx4 v[204:207], v5, s[40:43], s57 offen offset:2048 sc1
    buffer_load_dwordx4 v[208:211], v5, s[40:43], s57 offen offset:3072 sc1
    buffer_load_dwordx4 v[212:215], v7, s[40:43], s57 offen sc1
    s_cbranch_vccnz L_a_mre2
L_a_mok2:
    s_mov_b32 s96, 0
L_lw_90:
    ds_read_b128 v[96:99], v0 offset:96
    s_waitcnt lgkmcnt(0)
    v_min3_u32 v96, v96, v97, v98
    v_min_u32 v96, v96, v99
    s_nop 0
    v_readfirstlane_b32 s90, v96
    s_cmp_ge_i32 s90, 1
    s_cbranch_scc1 L_lwd_91
    s_sleep 1
    s_add_u32 s96, s96, 1
    s_cmp_lt_u32 s96, 2097152
    s_cbranch_scc1 L_lw_90
L_lwd_91:
    s_mov_b32 s96, 0
L_lw_92:
    ds_read_b128 v[96:99], v0 offset:48
    s_waitcnt lgkmcnt(0)
    v_min3_u32 v96, v96, v97, v98
    v_min_u32 v96, v96, v99
    s_nop 0
    v_readfirstlane_b32 s90, v96
    s_cmp_ge_i32 s90, 1
    s_cbranch_scc1 L_lwd_93
    s_sleep 1
    s_add_u32 s96, s96, 1
    s_cmp_lt_u32 s96, 2097152
    s_cbranch_scc1 L_lw_92
L_lwd_93:
    v_mfma_f32_16x16x32_bf16 v[16:19], v[216:219], v[128:131], v[16:19]
    v_mfma_f32_16x16x32_bf16 v[20:23], v[220:223], v[128:131], v[20:23]
    v_mfma_f32_16x16x32_bf16 v[24:27], v[224:227], v[128:131], v[24:27]
    v_mfma_f32_16x16x32_bf16 v[28:31], v[228:231], v[128:131], v[28:31]
    v_mfma_f32_16x16x32_bf16 v[32:35], v[232:235], v[128:131], v[32:35]
    v_mfma_f32_16x16x32_bf16 v[36:39], v[216:219], v[132:135], v[36:39]
    v_mfma_f32_16x16x32_bf16 v[40:43], v[220:223], v[132:135], v[40:43]
    v_mfma_f32_16x16x32_bf16 v[44:47], v[224:227], v[132:135], v[44:47]
    v_mfma_f32_16x16x32_bf16 v[48:51], v[228:231], v[132:135], v[48:51]
    v_mfma_f32_16x16x32_bf16 v[52:55], v[232:235], v[132:135], v[52:55]
    v_mfma_f32_16x16x32_bf16 v[56:59], v[216:219], v[136:139], v[56:59]
    v_mfma_f32_16x16x32_bf16 v[60:63], v[220:223], v[136:139], v[60:63]
    v_mfma_f32_16x16x32_bf16 v[64:67], v[224:227], v[136:139], v[64:67]
    v_mfma_f32_16x16x32_bf16 v[68:71], v[228:231], v[136:139], v[68:71]
    s_waitcnt vmcnt(5)
    v_max3_u32 v8, v176, v178, v180
    v_mfma_f32_16x16x32_bf16 v[72:75], v[232:235], v[136:139], v[72:75]
    v_max3_u32 v8, v8, v182, v184
    v_mfma_f32_16x16x32_bf16 v[76:79], v[216:219], v[140:143], v[76:79]
    v_max3_u32 v8, v8, v186, v188
    v_mfma_f32_16x16x32_bf16 v[80:83], v[220:223], v[140:143], v[80:83]
    v_max3_u32 v8, v8, v190, v192
    v_mfma_f32_16x16x32_bf16 v[84:87], v[224:227], v[140:143], v[84:87]
    v_max_u32 v8, v8, v194
    v_mfma_f32_16x16x32_bf16 v[88:91], v[228:231], v[140:143], v[88:91]
    v_cmp_eq_u32 vcc, -1, v8
    v_mfma_f32_16x16x32_bf16 v[92:95], v[232:235], v[140:143], v[92:95]
    s_cbranch_vccnz L_a_mre3
L_a_mok3:
    v_mfma_f32_16x16x32_bf16 v[16:19], v[176:179], v[144:147], v[16:19]
    s_waitcnt vmcnt(0)
    v_max3_u32 v8, v196, v198, v200
    v_max3_u32 v8, v8, v202, v204
    v_mfma_f32_16x16x32_bf16 v[20:23], v[180:183], v[144:147], v[20:23]
    v_max3_u32 v8, v8, v206, v208
    v_max3_u32 v8, v8, v210, v212
    v_mfma_f32_16x16x32_bf16 v[24:27], v[184:187], v[144:147], v[24:27]
    v_max_u32 v8, v8, v214
    v_cmp_eq_u32 vcc, -1, v8
    v_mfma_f32_16x16x32_bf16 v[28:31], v[188:191], v[144:147], v[28:31]
    v_mfma_f32_16x16x32_bf16 v[32:35], v[192:195], v[144:147], v[32:35]
    s_cbranch_vccnz L_a_mre4
L_a_mok4:
    v_mfma_f32_16x16x32_bf16 v[16:19], v[196:199], v[160:163], v[16:19]
    v_mfma_f32_16x16x32_bf16 v[20:23], v[200:203], v[160:163], v[20:23]
    s_lshl_b32 s48, s21, 8
    v_lshlrev_b32 v8, 2, v2
    v_mfma_f32_16x16x32_bf16 v[24:27], v[204:207], v[160:163], v[24:27]
    v_add_u32 v8, s48, v8
    ds_write_b32 v8, v14 offset:46080
    v_mfma_f32_16x16x32_bf16 v[28:31], v[208:211], v[160:163], v[28:31]
    v_mfma_f32_16x16x32_bf16 v[32:35], v[212:215], v[160:163], v[32:35]
    v_mfma_f32_16x16x32_bf16 v[36:39], v[176:179], v[148:151], v[36:39]
    v_mfma_f32_16x16x32_bf16 v[40:43], v[180:183], v[148:151], v[40:43]
    v_mfma_f32_16x16x32_bf16 v[44:47], v[184:187], v[148:151], v[44:47]
    v_mfma_f32_16x16x32_bf16 v[48:51], v[188:191], v[148:151], v[48:51]
    v_mfma_f32_16x16x32_bf16 v[52:55], v[192:195], v[148:151], v[52:55]
    ds_write_b128 v10, v[16:19] offset:0
    v_mfma_f32_16x16x32_bf16 v[36:39], v[196:199], v[164:167], v[36:39]
    ds_write_b128 v10, v[20:23] offset:1024
    v_mfma_f32_16x16x32_bf16 v[40:43], v[200:203], v[164:167], v[40:43]
    ds_write_b128 v10, v[24:27] offset:2048
    v_mfma_f32_16x16x32_bf16 v[44:47], v[204:207], v[164:167], v[44:47]
    ds_write_b128 v10, v[28:31] offset:3072
    v_mfma_f32_16x16x32_bf16 v[48:51], v[208:211], v[164:167], v[48:51]
    ds_write_b128 v10, v[32:35] offset:4096
    v_mfma_f32_16x16x32_bf16 v[52:55], v[212:215], v[164:167], v[52:55]
    v_mfma_f32_16x16x32_bf16 v[56:59], v[176:179], v[152:155], v[56:59]
    v_mfma_f32_16x16x32_bf16 v[60:63], v[180:183], v[152:155], v[60:63]
    v_mfma_f32_16x16x32_bf16 v[64:67], v[184:187], v[152:155], v[64:67]
    v_mfma_f32_16x16x32_bf16 v[68:71], v[188:191], v[152:155], v[68:71]
    v_mfma_f32_16x16x32_bf16 v[72:75], v[192:195], v[152:155], v[72:75]
    ds_write_b128 v11, v[36:39] offset:0
    v_mfma_f32_16x16x32_bf16 v[56:59], v[196:199], v[168:171], v[56:59]
    ds_write_b128 v11, v[40:43] offset:1024
    v_mfma_f32_16x16x32_bf16 v[60:63], v[200:203], v[168:171], v[60:63]
    ds_write_b128 v11, v[44:47] offset:2048
    v_mfma_f32_16x16x32_bf16 v[64:67], v[204:207], v[168:171], v[64:67]
    ds_write_b128 v11, v[48:51] offset:3072
    v_mfma_f32_16x16x32_bf16 v[68:71], v[208:211], v[168:171], v[68:71]
    ds_write_b128 v11, v[52:55] offset:4096
    v_mfma_f32_16x16x32_bf16 v[72:75], v[212:215], v[168:171], v[72:75]
    v_mfma_f32_16x16x32_bf16 v[88:91], v[188:191], v[156:159], v[88:91]
    v_mfma_f32_16x16x32_bf16 v[92:95], v[192:195], v[156:159], v[92:95]
    v_mfma_f32_16x16x32_bf16 v[76:79], v[176:179], v[156:159], v[76:79]
    v_mfma_f32_16x16x32_bf16 v[80:83], v[180:183], v[156:159], v[80:83]
    v_mfma_f32_16x16x32_bf16 v[84:87], v[184:187], v[156:159], v[84:87]
    ds_write_b128 v12, v[56:59] offset:0
    v_mfma_f32_16x16x32_bf16 v[88:91], v[208:211], v[172:175], v[88:91]
    ds_write_b128 v12, v[60:63] offset:1024
    v_mfma_f32_16x16x32_bf16 v[92:95], v[212:215], v[172:175], v[92:95]
    ds_write_b128 v12, v[64:67] offset:2048
    v_mfma_f32_16x16x32_bf16 v[76:79], v[196:199], v[172:175], v[76:79]
    ds_write_b128 v12, v[68:71] offset:3072
    v_mfma_f32_16x16x32_bf16 v[80:83], v[200:203], v[172:175], v[80:83]
    ds_write_b128 v12, v[72:75] offset:4096
    v_mfma_f32_16x16x32_bf16 v[84:87], v[204:207], v[172:175], v[84:87]
    s_nop 1
    ds_write_b128 v13, v[88:91] offset:3072
    ds_write_b128 v13, v[92:95] offset:4096
    s_mul_i32 s50, s21, 15360
    s_cmp_eq_u32 s21, 3
    s_cselect_b32 s50, 131072, s50
    s_mul_i32 s48, s21, 20480
    s_add_u32 s48, s48, 49152
    v_add_u32 v8, s48, v5
    v_mov_b32 v15, v14
    v_add_u32 v7, s50, v5
    s_lshl_b32 s48, s18, 6
    s_lshl_b32 s49, s21, 4
    s_add_u32 s48, s48, s49
    v_add_u32 v9, s48, v4
    v_mul_u32_u24 v9, 1280, v9
    v_lshl_add_u32 v9, v3, 3, v9
    s_mul_i32 s48, s19, 160
    s_waitcnt lgkmcnt(0)
    s_barrier
    ds_read_b128 v[96:99], v8 offset:0
    ds_read_b128 v[100:103], v8 offset:1024
    ds_read_b128 v[104:107], v8 offset:2048
    ds_read_b128 v[108:111], v8 offset:5120
    ds_read_b128 v[112:115], v8 offset:6144
    ds_read_b128 v[116:119], v8 offset:7168
    ds_read_b128 v[120:123], v8 offset:10240
    ds_read_b128 v[124:127], v8 offset:11264
    ds_read_b128 v[128:131], v8 offset:12288
    ds_read_b128 v[132:135], v8 offset:15360
    ds_read_b128 v[136:139], v8 offset:16384
    ds_read_b128 v[140:143], v8 offset:17408
    s_waitcnt lgkmcnt(6)
    ds_read_b128 v[16:19], v7 offset:0
    ds_read_b128 v[20:23], v7 offset:1024
    ds_read_b128 v[24:27], v7 offset:2048
    ds_read_b128 v[28:31], v7 offset:5120
    ds_read_b128 v[32:35], v7 offset:6144
    ds_read_b128 v[36:39], v7 offset:7168
    ds_read_b128 v[40:43], v7 offset:10240
    ds_read_b128 v[44:47], v7 offset:11264
    ds_read_b128 v[48:51], v7 offset:12288
    v_pk_add_f32 v[96:97], v[96:97], v[108:109]
    v_pk_add_f32 v[98:99], v[98:99], v[110:111]
    v_pk_add_f32 v[100:101], v[100:101], v[112:113]
    v_pk_add_f32 v[102:103], v[102:103], v[114:115]
    v_pk_add_f32 v[104:105], v[104:105], v[116:117]
    v_pk_add_f32 v[106:107], v[106:107], v[118:119]
    s_waitcnt lgkmcnt(9)
    v_pk_add_f32 v[120:121], v[120:121], v[132:133]
    v_pk_add_f32 v[122:123], v[122:123], v[134:135]
    v_pk_add_f32 v[124:125], v[124:125], v[136:137]
    v_pk_add_f32 v[126:127], v[126:127], v[138:139]
    v_pk_add_f32 v[128:129], v[128:129], v[140:141]
    v_pk_add_f32 v[130:131], v[130:131], v[142:143]
    v_pk_add_f32 v[96:97], v[96:97], v[120:121]
    v_pk_add_f32 v[98:99], v[98:99], v[122:123]
    v_pk_add_f32 v[100:101], v[100:101], v[124:125]
    v_pk_add_f32 v[102:103], v[102:103], v[126:127]
    v_pk_add_f32 v[104:105], v[104:105], v[128:129]
    v_pk_add_f32 v[106:107], v[106:107], v[130:131]
    v_pk_fma_f32 v[76:77], v[96:97], v[14:15], v[76:77]
    v_pk_fma_f32 v[78:79], v[98:99], v[14:15], v[78:79]
    v_pk_fma_f32 v[80:81], v[100:101], v[14:15], v[80:81]
    v_pk_fma_f32 v[82:83], v[102:103], v[14:15], v[82:83]
    v_pk_fma_f32 v[84:85], v[104:105], v[14:15], v[84:85]
    v_pk_fma_f32 v[86:87], v[106:107], v[14:15], v[86:87]
    s_waitcnt lgkmcnt(6)
    v_pk_add_f32 v[76:77], v[76:77], v[16:17]
    v_pk_add_f32 v[78:79], v[78:79], v[18:19]
    v_pk_add_f32 v[80:81], v[80:81], v[20:21]
    v_pk_add_f32 v[82:83], v[82:83], v[22:23]
    v_pk_add_f32 v[84:85], v[84:85], v[24:25]
    v_pk_add_f32 v[86:87], v[86:87], v[26:27]
    s_waitcnt lgkmcnt(3)
    v_pk_add_f32 v[76:77], v[76:77], v[28:29]
    v_pk_add_f32 v[78:79], v[78:79], v[30:31]
    v_pk_add_f32 v[80:81], v[80:81], v[32:33]
    v_pk_add_f32 v[82:83], v[82:83], v[34:35]
    v_pk_add_f32 v[84:85], v[84:85], v[36:37]
    v_pk_add_f32 v[86:87], v[86:87], v[38:39]
    s_waitcnt lgkmcnt(0)
    v_pk_add_f32 v[76:77], v[76:77], v[40:41]
    v_pk_add_f32 v[78:79], v[78:79], v[42:43]
    v_pk_add_f32 v[80:81], v[80:81], v[44:45]
    v_pk_add_f32 v[82:83], v[82:83], v[46:47]
    v_pk_add_f32 v[84:85], v[84:85], v[48:49]
    v_pk_add_f32 v[86:87], v[86:87], v[50:51]
    v_cvt_pk_bf16_f32 v76, v76, v77
    v_cvt_pk_bf16_f32 v77, v78, v79
    buffer_store_dwordx2 v[76:77], v9, s[28:31], s48 offen offset:0
    v_cvt_pk_bf16_f32 v80, v80, v81
    v_cvt_pk_bf16_f32 v81, v82, v83
    buffer_store_dwordx2 v[80:81], v9, s[28:31], s48 offen offset:32
    v_cvt_pk_bf16_f32 v84, v84, v85
    v_cvt_pk_bf16_f32 v85, v86, v87
    buffer_store_dwordx2 v[84:85], v9, s[28:31], s48 offen offset:64
    s_endpgm
L_a_mre0:
    s_mov_b32 s96, 0
L_a_mrl0:
    s_sleep 4
    s_add_u32 s57, s55, 0
    buffer_load_dwordx4 v[176:179], v5, s[40:43], s57 offen offset:0 sc1
    buffer_load_dwordx4 v[180:183], v5, s[40:43], s57 offen offset:1024 sc1
    buffer_load_dwordx4 v[184:187], v5, s[40:43], s57 offen offset:2048 sc1
    buffer_load_dwordx4 v[188:191], v5, s[40:43], s57 offen offset:3072 sc1
    buffer_load_dwordx4 v[192:195], v7, s[40:43], s57 offen sc1
    s_waitcnt vmcnt(0)
    v_max3_u32 v8, v176, v178, v180
    v_max3_u32 v8, v8, v182, v184
    v_max3_u32 v8, v8, v186, v188
    v_max3_u32 v8, v8, v190, v192
    v_max_u32 v8, v8, v194
    v_cmp_eq_u32 vcc, -1, v8
    s_cbranch_vccz L_a_mok0
    s_add_u32 s96, s96, 1
    s_cmp_lt_u32 s96, 131072
    s_cbranch_scc1 L_a_mrl0
    s_branch L_a_mok0
L_a_mre1:
    s_mov_b32 s96, 0
L_a_mrl1:
    s_sleep 4
    s_add_u32 s57, s55, 5120
    buffer_load_dwordx4 v[196:199], v5, s[40:43], s57 offen offset:0 sc1
    buffer_load_dwordx4 v[200:203], v5, s[40:43], s57 offen offset:1024 sc1
    buffer_load_dwordx4 v[204:207], v5, s[40:43], s57 offen offset:2048 sc1
    buffer_load_dwordx4 v[208:211], v5, s[40:43], s57 offen offset:3072 sc1
    buffer_load_dwordx4 v[212:215], v7, s[40:43], s57 offen sc1
    s_waitcnt vmcnt(0)
    v_max3_u32 v8, v196, v198, v200
    v_max3_u32 v8, v8, v202, v204
    v_max3_u32 v8, v8, v206, v208
    v_max3_u32 v8, v8, v210, v212
    v_max_u32 v8, v8, v214
    v_cmp_eq_u32 vcc, -1, v8
    s_cbranch_vccz L_a_mok1
    s_add_u32 s96, s96, 1
    s_cmp_lt_u32 s96, 131072
    s_cbranch_scc1 L_a_mrl1
    s_branch L_a_mok1
L_a_mre2:
    s_mov_b32 s96, 0
L_a_mrl2:
    s_sleep 4
    s_add_u32 s57, s55, 10240
    buffer_load_dwordx4 v[216:219], v5, s[40:43], s57 offen offset:0 sc1
    buffer_load_dwordx4 v[220:223], v5, s[40:43], s57 offen offset:1024 sc1
    buffer_load_dwordx4 v[224:227], v5, s[40:43], s57 offen offset:2048 sc1
    buffer_load_dwordx4 v[228:231], v5, s[40:43], s57 offen offset:3072 sc1
    buffer_load_dwordx4 v[232:235], v7, s[40:43], s57 offen sc1
    s_waitcnt vmcnt(0)
    v_max3_u32 v8, v216, v218, v220
    v_max3_u32 v8, v8, v222, v224
    v_max3_u32 v8, v8, v226, v228
    v_max3_u32 v8, v8, v230, v232
    v_max_u32 v8, v8, v234
    v_cmp_eq_u32 vcc, -1, v8
    s_cbranch_vccz L_a_mok2
    s_add_u32 s96, s96, 1
    s_cmp_lt_u32 s96, 131072
    s_cbranch_scc1 L_a_mrl2
    s_branch L_a_mok2
L_a_mre3:
    s_mov_b32 s96, 0
L_a_mrl3:
    s_sleep 4
    s_add_u32 s57, s55, 15360
    buffer_load_dwordx4 v[176:179], v5, s[40:43], s57 offen offset:0 sc1
    buffer_load_dwordx4 v[180:183], v5, s[40:43], s57 offen offset:1024 sc1
    buffer_load_dwordx4 v[184:187], v5, s[40:43], s57 offen offset:2048 sc1
    buffer_load_dwordx4 v[188:191], v5, s[40:43], s57 offen offset:3072 sc1
    buffer_load_dwordx4 v[192:195], v7, s[40:43], s57 offen sc1
    s_waitcnt vmcnt(0)
    v_max3_u32 v8, v176, v178, v180
    v_max3_u32 v8, v8, v182, v184
    v_max3_u32 v8, v8, v186, v188
    v_max3_u32 v8, v8, v190, v192
    v_max_u32 v8, v8, v194
    v_cmp_eq_u32 vcc, -1, v8
    s_cbranch_vccz L_a_mok3
    s_add_u32 s96, s96, 1
    s_cmp_lt_u32 s96, 131072
    s_cbranch_scc1 L_a_mrl3
    s_branch L_a_mok3
L_a_mre4:
    s_mov_b32 s96, 0
L_a_mrl4:
    s_sleep 4
    s_add_u32 s57, s55, 20480
    buffer_load_dwordx4 v[196:199], v5, s[40:43], s57 offen offset:0 sc1
    buffer_load_dwordx4 v[200:203], v5, s[40:43], s57 offen offset:1024 sc1
    buffer_load_dwordx4 v[204:207], v5, s[40:43], s57 offen offset:2048 sc1
    buffer_load_dwordx4 v[208:211], v5, s[40:43], s57 offen offset:3072 sc1
    buffer_load_dwordx4 v[212:215], v7, s[40:43], s57 offen sc1
    s_waitcnt vmcnt(0)
    v_max3_u32 v8, v196, v198, v200
    v_max3_u32 v8, v8, v202, v204
    v_max3_u32 v8, v8, v206, v208
    v_max3_u32 v8, v8, v210, v212
    v_max_u32 v8, v8, v214
    v_cmp_eq_u32 vcc, -1, v8
    s_cbranch_vccz L_a_mok4
    s_add_u32 s96, s96, 1
    s_cmp_lt_u32 s96, 131072
    s_cbranch_scc1 L_a_mrl4
    s_branch L_a_mok4
L_end:
    s_endpgm
    .p2align 7
L_table:
    .long 0
    .long 1
    .long 2
    .long 3
    .long 4
    .long 5
    .long 6
    .long 7
    .long 8
    .long 9
    .long 10
    .long 11
    .long 12
    .long 13
    .long 14
    .long 15
    .long 16
    .long 17
    .long 18
    .long 19
    .long 20
    .long 21
    .long 22
    .long 23
    .long 24
    .long 25
    .long 26
    .long 27
    .long 28
    .long 29
    .long 30
    .long 31
.section .rodata,"a"
.p2align 6
.amdhsa_kernel gated_mix__linear_attn_block__glu_gated_glu__prompt_kernel
  .amdhsa_next_free_vgpr 256
  .amdhsa_next_free_sgpr 102
  .amdhsa_accum_offset 256
  .amdhsa_group_segment_fixed_size 0
  .amdhsa_kernarg_size 88
  .amdhsa_user_sgpr_count 2
  .amdhsa_user_sgpr_kernarg_segment_ptr 1
  .amdhsa_system_sgpr_workgroup_id_x 1
.end_amdhsa_kernel
```
